```python
import torch

def _softmax(x, axis=-1):
    return torch.softmax(x, dim=axis)
def _gelu(x):
    return torch.nn.functional.gelu(x, approximate="tanh")
def _silu(x):
    return torch.nn.functional.silu(x)
def _sigmoid(x):
    return torch.sigmoid(x)
def _layernorm(x, axis=-1, eps=1e-5):
    m = x.mean(dim=axis, keepdim=True)
    v = x.var(dim=axis, keepdim=True, unbiased=False)
    return (x - m) / torch.sqrt(v + eps)
def _scatter_add(tgt, idx, src, axis=0):
    return tgt.clone().index_add_(axis, idx, src)
def _segment_sum(src, seg, n):
    out = torch.zeros((n,) + src.shape[1:], dtype=src.dtype)
    return out.index_add_(0, seg, src)
def _pad(x, pw):
    flat = tuple(v for pair in reversed(pw) for v in pair)
    return torch.nn.functional.pad(x, flat)

kernel_name = 'recurrent_scan__spectral_gfnet__mixer_s_mlp__prompt'

def setup_inputs():

    _w = (lambda a: (lambda t: t.to(torch.bfloat16) if t.is_floating_point() else t)(torch.as_tensor(a)))
    def _A_setup():
        B, S, D = 1, 2048, 512
        Df = D // 2 + 1
        return {
            "x": _w((lambda *s: torch.randn(*s, dtype=torch.bfloat16) * 0.05)(B, S, D)),
            "w_r": _w((lambda *s: torch.randn(*s, dtype=torch.bfloat16) * 0.2)(S, Df) * 0.02),
            "w_i": _w((lambda *s: torch.randn(*s, dtype=torch.bfloat16) * 0.2)(S, Df) * 0.02),
        }
    _A_in = _A_setup()

    def _B_setup():
        B, S, D, F = 1, 2048, 512, 1792
        return {
            "x":  _w((lambda *s: torch.randn(*s, dtype=torch.bfloat16) * 0.05)(B, S, D)),
            "w1": _w((lambda *s: torch.randn(*s, dtype=torch.bfloat16) * 1.6)(D, D) * (D ** -0.5)),
            "w2": _w((lambda *s: torch.randn(*s, dtype=torch.bfloat16) * 1.6)(D, D) * (D ** -0.5)),
            "w3": _w((lambda *s: torch.randn(*s, dtype=torch.bfloat16) * 1.6)(D, F) * (D ** -0.5)),
            "w4": _w((lambda *s: torch.randn(*s, dtype=torch.bfloat16) * 1.6)(F, D) * (F ** -0.5)),
        }
    _B_in = _B_setup()

    return {
        "A_x": _A_in["x"],
        "A_w_r": _A_in["w_r"],
        "A_w_i": _A_in["w_i"],
        "B_x": _B_in["x"],
        "B_w1": _B_in["w1"],
        "B_w2": _B_in["w2"],
        "B_w3": _B_in["w3"],
        "B_w4": _B_in["w4"],
    }

def reference(A_x, A_w_r, A_w_i, B_x, B_w1, B_w2, B_w3, B_w4):
    def _A_ref(x, w_r, w_i):
        B, S, D = x.shape
        X = (lambda x, axes=(-2,-1): torch.fft.rfft2(x.float(), dim=axes))(x, axes=(-2, -1))
        W = w_r + 1j * w_i
        X = X * W
        y = (lambda x, s, axes=(-2,-1): torch.fft.irfft2(x, s=s, dim=axes).to(torch.bfloat16))(X, (S, D), axes=(-2, -1))
        return y

    def _B_ref(x, w1, w2, w3, w4):
        B, S, D = x.shape
        h = _gelu(_layernorm(x, axis=-1) @ w1)
        c = D // 4
        g0 = _pad(h[:, :, 0*c:1*c], ((0, 0), (1, 0), (0, 0)))[:, :S, :]
        g1 = _pad(h[:, :, 1*c:2*c], ((0, 0), (0, 1), (0, 0)))[:, 1:, :]
        g2 = _pad(h[:, :, 2*c:3*c], ((0, 0), (2, 0), (0, 0)))[:, :S, :]
        g3 = _pad(h[:, :, 3*c:   ], ((0, 0), (0, 2), (0, 0)))[:, 2:, :]
        hs = torch.concatenate([g0, g1, g2, g3], axis=-1) @ w2
        x1 = x + hs
        h2 = _gelu(_layernorm(x1, axis=-1) @ w3) @ w4
        return x1 + h2

    x = A_x
    xn = _layernorm(x, axis=-1)
    s = _A_ref(xn, A_w_r, A_w_i)
    g = _silu(_B_ref(xn, B_w1, B_w2, B_w3, B_w4))
    return x + s * g
```

```asm
; @launch grid=(256,1,1) block=(256,1,1) lds=163840
.amdgcn_target "amdgcn-amd-amdhsa--gfx950"
.text
.globl recurrent_scan__spectral_gfnet__mixer_s_mlp__prompt_kernel
.p2align 8
.type recurrent_scan__spectral_gfnet__mixer_s_mlp__prompt_kernel,@function
recurrent_scan__spectral_gfnet__mixer_s_mlp__prompt_kernel:
    s_load_dwordx2 s[4:5], s[0:1], 0
    s_load_dwordx2 s[8:9], s[0:1], 32
    s_cmp_ge_u32 s2, 0x100
    s_cbranch_scc1 L_end
    s_getpc_b64 s[44:45]
L_pc:
    s_mov_b32 s46, L_code_end-L_pc
    s_mov_b32 s47, 0x20000
    s_lshr_b32 s52, s2, 3
    s_and_b32 s53, s2, 7
    s_lshl_b32 s56, s52, 11
    v_lshlrev_b32 v4, 3, v0
    v_lshrrev_b32 v5, 6, v0
    buffer_load_dword v45, v4, s[44:47], s56 offen
    v_readfirstlane_b32 s48, v5
    v_bfe_u32 v37, v0, 3, 3
    v_and_b32 v38, 7, v0
    s_lshr_b32 s56, s52, 3
    s_lshl2_add_u32 s49, s53, s56
    s_and_b32 s50, s52, 7
    s_add_u32 s56, s56, s50
    s_and_b32 s3, s56, 3
    s_lshl_b32 s72, s3, 8
    s_add_u32 s73, s72, 128
    s_lshr_b32 s56, s50, 2
    s_add_u32 s51, s56, 1
    s_sub_u32 s56, 0, s51
    s_bitcmp1_b32 s50, 1
    s_cselect_b32 s51, s56, s51
    s_lshl_b32 s58, s49, 6
    s_lshl4_add_u32 s58, s48, s58
    s_sub_u32 s57, s58, s51
    v_lshrrev_b32 v4, 1, v37
    v_xor_b32 v4, v4, v38
    v_lshlrev_b32 v4, 4, v4
    v_xor_b32 v5, 64, v4
    v_add_u32 v6, s57, v37
    v_add_u32 v7, 8, v6
    v_and_b32 v6, 0x7ff, v6
    v_lshl_or_b32 v46, v6, 10, v4
    v_and_b32 v7, 0x7ff, v7
    v_lshl_or_b32 v47, v7, 10, v5
    s_lshl_b32 s64, s48, 11
    s_mov_b32 s6, 0x200000
    s_mov_b32 s7, 0x20000
    s_mov_b32 s10, 0x80000
    s_mov_b32 s11, 0x20000
    s_waitcnt lgkmcnt(0)
    s_add_u32 m0, s64, 0x0
    s_nop 0
    buffer_load_dwordx4 v46, s[4:7], s72 offen lds
    s_add_u32 m0, s64, 0x400
    s_nop 0
    buffer_load_dwordx4 v47, s[4:7], s72 offen lds
    s_load_dwordx2 s[12:13], s[0:1], 80
    s_load_dwordx2 s[16:17], s[0:1], 8
    s_load_dwordx2 s[20:21], s[0:1], 16
    s_load_dwordx2 s[24:25], s[0:1], 40
    s_load_dwordx2 s[28:29], s[0:1], 48
    s_load_dwordx2 s[32:33], s[0:1], 56
    s_load_dwordx2 s[36:37], s[0:1], 64
    s_load_dwordx2 s[40:41], s[0:1], 72
    v_and_b32 v8, 2, v37
    v_lshlrev_b32 v8, 1, v8
    v_xor_b32 v8, v8, v38
    v_lshlrev_b32 v39, 4, v8
    s_lshl_b32 s57, s48, 14
    s_lshl_b32 s59, s50, 7
    s_add_u32 s57, s57, s59
    v_lshl_or_b32 v50, v37, 10, v39
    v_add_u32 v50, s57, v50
    v_add_u32 v51, 0x2000, v50
    s_add_u32 m0, s64, 0x10000
    s_lshl_b32 s65, s72, 9
    buffer_load_dwordx4 v50, s[8:11], s65 offen lds
    s_add_u32 m0, s64, 0x10400
    s_lshl_b32 s65, s72, 9
    buffer_load_dwordx4 v51, s[8:11], s65 offen lds
    s_add_u32 s74, s72, 256
    s_and_b32 s74, s74, 0x3ff
    s_add_u32 s75, s74, 128
    s_add_u32 m0, s64, 0x2000
    s_nop 0
    buffer_load_dwordx4 v46, s[4:7], s73 offen lds
    s_add_u32 m0, s64, 0x2400
    s_nop 0
    buffer_load_dwordx4 v47, s[4:7], s73 offen lds
    s_add_u32 m0, s64, 0x12000
    s_lshl_b32 s65, s73, 9
    buffer_load_dwordx4 v50, s[8:11], s65 offen lds
    s_add_u32 m0, s64, 0x12400
    s_lshl_b32 s65, s73, 9
    buffer_load_dwordx4 v51, s[8:11], s65 offen lds
    s_add_u32 m0, s64, 0x4000
    s_nop 0
    buffer_load_dwordx4 v46, s[4:7], s74 offen lds
    s_add_u32 m0, s64, 0x4400
    s_nop 0
    buffer_load_dwordx4 v47, s[4:7], s74 offen lds
    s_add_u32 m0, s64, 0x6000
    s_nop 0
    buffer_load_dwordx4 v46, s[4:7], s75 offen lds
    s_add_u32 m0, s64, 0x6400
    s_nop 0
    buffer_load_dwordx4 v47, s[4:7], s75 offen lds
    s_add_u32 s76, s72, 512
    s_and_b32 s76, s76, 0x3ff
    s_add_u32 s77, s76, 128
    s_add_u32 s78, s72, 768
    s_and_b32 s78, s78, 0x3ff
    s_add_u32 s79, s78, 128
    s_lshl_b32 s57, s58, 10
    s_lshl_b32 s59, s50, 7
    s_add_u32 s57, s57, s59
    v_lshl_or_b32 v48, v37, 10, v4
    v_add_u32 v48, s57, v48
    v_lshl_or_b32 v49, v37, 10, v5
    v_add_u32 v49, s57, v49
    v_add_u32 v49, 0x2000, v49
    v_and_b32 v34, 63, v0
    s_sub_u32 s57, s2, 224
    s_lshl_b32 s56, s57, 13
    s_add_u32 s56, s56, 0x1300000
    s_lshl_b32 s71, s48, 8
    s_add_u32 s71, s71, s57
    s_cmp_lt_u32 s71, 12
    s_cselect_b32 s56, s56, 0x7f000000
    v_lshlrev_b32 v4, 7, v34
    v_add_u32 v4, s56, v4
    v_mov_b32 v5, 0
    s_mov_b32 s47, 0
    s_mov_b32 s80, 1
    s_mov_b32 s14, 0x1700000
    s_mov_b32 s15, 0x20000
    s_mov_b32 s18, 0x101000
    s_mov_b32 s19, 0x20000
    s_mov_b32 s22, 0x101000
    s_mov_b32 s23, 0x20000
    s_mov_b32 s26, 0x80000
    s_mov_b32 s27, 0x20000
    s_mov_b32 s30, 0x1c0000
    s_mov_b32 s31, 0x20000
    s_mov_b32 s34, 0x1c0000
    s_mov_b32 s35, 0x20000
    s_mov_b32 s38, 0x200000
    s_mov_b32 s39, 0x20000
    s_mov_b32 s42, 0x100
    s_mov_b32 s43, 0x20000
    s_waitcnt lgkmcnt(0)
    buffer_store_dword v5, v4, s[12:15], 0 offen sc1
    s_and_b32 s54, s48, 1
    s_lshr_b32 s55, s48, 1
    v_mov_b32 v32, 1
    v_and_b32 v35, 31, v0
    v_bfe_u32 v36, v0, 5, 1
    v_lshlrev_b32 v30, 4, v34
    v_lshlrev_b32 v44, 7, v38
    v_and_b32 v43, 0x180, v44
    v_mov_b32 v2, 0x3f803f80
    v_mov_b32 v3, 0x3f803f80
    s_lshl_b32 s56, s55, 5
    v_add_u32 v8, s56, v35
    v_bfe_u32 v7, v8, 1, 3
    v_xor_b32 v6, v7, v36
    v_lshlrev_b32 v6, 4, v6
    v_lshl_or_b32 v52, v8, 7, v6
    v_xor_b32 v53, 32, v52
    v_xor_b32 v54, 64, v52
    v_xor_b32 v55, 96, v52
    s_lshl_b32 s56, s54, 2
    v_xor_b32 v7, s56, v7
    v_lshlrev_b32 v7, 4, v7
    v_lshl_or_b32 v7, v36, 3, v7
    v_lshl_or_b32 v62, v8, 7, v7
    v_add_u32 v62, 0x10000, v62
    s_lshl_b32 s56, s48, 1
    v_bfe_u32 v5, v34, 1, 3
    v_xor_b32 v5, s56, v5
    v_lshlrev_b32 v5, 4, v5
    v_lshl_or_b32 v56, v34, 7, v5
    v_xor_b32 v57, 16, v56
    v_bfe_u32 v4, v34, 4, 1
    v_lshlrev_b32 v4, 1, v4
    v_bfe_u32 v5, v34, 1, 1
    v_or_b32 v4, v4, v5
    v_bfe_u32 v5, v34, 3, 1
    v_lshl_or_b32 v4, v5, 2, v4
    v_lshlrev_b32 v4, 4, v4
    v_and_b32 v5, 1, v34
    v_lshl_or_b32 v4, v5, 3, v4
    v_bfe_u32 v5, v34, 2, 2
    v_lshl_or_b32 v31, v5, 7, v4
    s_lshl_b32 s56, s54, 6
    v_lshl_or_b32 v4, v36, 10, v31
    v_xor_b32 v4, s56, v4
    v_add_u32 v58, 0x10000, v4
    v_lshl_or_b32 v4, v36, 9, v31
    v_xor_b32 v59, s56, v4
    s_add_u32 s56, s64, 0x20000
    v_add_u32 v60, s56, v4
    v_xor_b32 v61, 64, v60
    v_lshlrev_b32 v4, 6, v36
    v_xor_b32 v4, v4, v31
    s_add_u32 s56, s64, 0x22000
    v_add_u32 v63, s56, v4
    s_lshl_b32 s56, s52, 16
    s_lshl_b32 s59, s48, 14
    s_add_u32 s56, s56, s59
    s_lshl_b32 s59, s53, 7
    s_add_u32 s56, s56, s59
    v_lshl_or_b32 v4, v37, 10, v39
    v_add_u32 v64, s56, v4
    s_mul_i32 s57, s53, 229376
    s_lshl_b32 s56, s52, 13
    s_lshl_b32 s59, s48, 11
    s_add_u32 s56, s56, s59
    s_add_u32 s56, s56, s57
    s_add_u32 s56, s56, 0x1400000
    s_cmp_lt_u32 s52, 28
    s_cselect_b32 s56, s56, 0x7f000000
    v_add_u32 v66, s56, v30
    s_lshr_b32 s56, s52, 2
    s_lshl_b32 s56, s56, 3
    s_lshl1_add_u32 s56, s48, s56
    s_lshl_b32 s59, s53, 8
    s_add_u32 s56, s56, s59
    v_and_b32 v4, 3, v37
    v_lshlrev_b32 v4, 6, v4
    v_lshrrev_b32 v5, 2, v37
    v_add3_u32 v4, v4, v5, s56
    v_mul_u32_u24 v4, 514, v4
    s_and_b32 s56, s52, 3
    s_lshl_b32 s56, s56, 7
    s_add_u32 s56, s56, 0x2
    v_add3_u32 v65, v4, s56, v39
    s_lshl_b32 s56, s49, 16
    s_lshl_b32 s59, s55, 15
    s_add_u32 s56, s56, s59
    s_lshl_b32 s59, s50, 7
    s_add_u32 s56, s56, s59
    s_lshl_b32 s59, s54, 6
    s_add_u32 s56, s56, s59
    v_lshlrev_b32 v1, 10, v35
    v_add_u32 v1, s56, v1
    s_lshl_b32 s58, s48, 1
    v_xor_b32 v5, s58, v38
    v_lshlrev_b32 v5, 4, v5
    v_lshl_or_b32 v4, v34, 7, v5
    v_add_u32 v68, 0x16000, v4
    v_xor_b32 v69, 16, v68
    s_add_u32 s56, s64, 0x16000
    v_xor_b32 v5, v37, v38
    v_lshlrev_b32 v5, 4, v5
    v_lshl_or_b32 v4, v37, 7, v5
    v_add_u32 v67, s56, v4
    s_mov_b32 s57, 8320
    v_lshlrev_b32 v7, 4, v38
    s_and_b32 s56, s52, 3
    s_lshl_b32 s56, s56, 6
    s_lshl4_add_u32 s56, s48, s56
    s_add_u32 s56, s56, 0x1
    v_add_u32 v4, s56, v37
    v_add_u32 v5, 8, v4
    v_and_b32 v4, 0xff, v4
    v_mad_u32_u24 v70, v4, s57, v7
    v_and_b32 v5, 0xff, v5
    v_mad_u32_u24 v71, v5, s57, v7
    s_lshr_b32 s58, s52, 3
    s_and_b32 s56, s52, 4
    s_lshl_b32 s46, s58, 11
    s_lshl_b32 s59, s53, 8
    s_add_u32 s46, s46, s59
    s_lshl_b32 s59, s56, 5
    s_add_u32 s46, s46, s59
    s_add_u32 s46, s46, 0x900000
    s_lshl_b32 s56, s54, 5
    v_add_u32 v4, s56, v35
    s_lshl_b32 s56, s55, 2
    v_xor_b32 v5, s56, v38
    v_lshlrev_b32 v5, 4, v5
    v_lshl_or_b32 v4, v4, 7, v5
    v_lshl_or_b32 v4, v36, 3, v4
    v_add_u32 v72, 0x24000, v4
    v_xor_b32 v73, 16, v72
    v_xor_b32 v74, 32, v72
    v_xor_b32 v75, 48, v72
    v_add_u32 v76, 0xe000, v67
    s_mov_b32 s57, 8320
    v_lshlrev_b32 v7, 4, v38
    v_and_b32 v4, 1, v37
    v_lshl_or_b32 v4, v4, 12, v7
    v_lshrrev_b32 v5, 1, v37
    v_mad_u32_u24 v77, v5, s57, v4
    s_lshl_b32 s56, s50, 5
    s_lshl3_add_u32 s56, s48, s56
    s_mul_i32 s56, s56, 8320
    s_lshl_b32 s44, s49, 7
    s_add_u32 s44, s44, s56
    s_add_u32 s44, s44, 0x400000
    s_add_u32 s45, s44, 33280
    s_lshl_b32 s67, s49, 16
    s_lshl_b32 s59, s55, 15
    s_add_u32 s67, s67, s59
    s_lshl_b32 s59, s50, 12
    s_add_u32 s67, s67, s59
    s_lshl_b32 s59, s54, 11
    s_add_u32 s67, s67, s59
    s_lshl_b32 s66, s49, 9
    s_lshl_b32 s59, s48, 7
    s_add_u32 s66, s66, s59
    s_add_u32 s66, s66, 0x1300000
    s_lshl_b32 s56, s49, 10
    s_lshl_b32 s59, s48, 8
    s_add_u32 s56, s56, s59
    s_add_u32 s56, s56, 0x1280000
    s_and_b32 s58, s50, 5
    s_cmp_eq_u32 s58, 0
    s_cselect_b32 s56, s56, 0x7f000000
    v_subrev_u32 v4, s51, v34
    v_cmp_gt_u32 vcc, 32, v4
    v_lshl_add_u32 v4, v4, 3, s56
    v_mov_b32 v5, 0x7f000000
    v_cndmask_b32 v4, v5, v4, vcc
    v_cmp_eq_u32 vcc, 0, v36
    s_nop 1
    v_cndmask_b32 v78, v5, v4, vcc
    s_lshl_b32 s56, s50, 6
    s_lshl_b32 s59, s54, 5
    s_add_u32 s56, s56, s59
    v_add_u32 v4, s56, v35
    v_lshrrev_b32 v5, 1, v4
    v_mov_b32 v8, 0x100
    v_cmp_eq_u32 vcc, 0, v4
    s_nop 1
    v_cndmask_b32 v5, v5, v8, vcc
    v_lshlrev_b32 v114, 31, v5
    v_or_b32 v114, 1.0, v114
    v_mul_u32_u24 v9, s3, v5
    v_lshlrev_b32 v6, 30, v9
    v_and_b32 v6, 0x80000000, v6
    v_or_b32 v6, 1.0, v6
    v_lshlrev_b32 v7, 31, v4
    v_xor_b32 v7, v7, v6
    v_and_b32 v9, 1, v9
    v_cmp_eq_u32 vcc, 0, v9
    s_nop 1
    v_cndmask_b32 v116, 0, v6, vcc
    v_cndmask_b32 v118, v7, 0, vcc
    s_add_u32 s3, s3, 1
    v_mul_u32_u24 v9, s3, v5
    v_lshlrev_b32 v6, 30, v9
    v_and_b32 v6, 0x80000000, v6
    v_or_b32 v6, 1.0, v6
    v_lshlrev_b32 v7, 31, v4
    v_xor_b32 v7, v7, v6
    v_and_b32 v9, 1, v9
    v_cmp_eq_u32 vcc, 0, v9
    s_nop 1
    v_cndmask_b32 v117, 0, v6, vcc
    v_cndmask_b32 v119, v7, 0, vcc
    v_cvt_f32_u32 v79, v5
    v_mul_f32 v79, 0x3b000000, v79
    v_and_b32 v4, 1, v4
    v_cvt_f32_u32 v4, v4
    v_mul_f32 v4, 0x3e800000, v4
    v_cvt_f32_u32 v5, v36
    v_mul_f32 v5, 0x41000000, v5
    v_fma_f32 v112, v5, v79, v4
    v_mul_f32 v4, 0x41800000, v79
    v_cos_f32 v136, v4
    v_fmamk_f32 v4, v79, 0x00000000, v112
    v_fmamk_f32 v5, v79, 0x3f800000, v112
    v_fmamk_f32 v6, v79, 0x40000000, v112
    v_fmamk_f32 v7, v79, 0x40400000, v112
    v_fmamk_f32 v8, v79, 0x40800000, v112
    v_fmamk_f32 v9, v79, 0x40a00000, v112
    v_fmamk_f32 v10, v79, 0x40c00000, v112
    v_fmamk_f32 v11, v79, 0x40e00000, v112
    v_cos_f32 v120, v4
    v_cos_f32 v121, v5
    v_cos_f32 v122, v6
    v_cos_f32 v123, v7
    v_cos_f32 v124, v8
    v_cos_f32 v125, v9
    v_cos_f32 v126, v10
    v_cos_f32 v127, v11
    v_cvt_pk_bf16_f32 v80, v120, v121
    v_cvt_pk_bf16_f32 v81, v122, v123
    v_cvt_pk_bf16_f32 v82, v124, v125
    v_cvt_pk_bf16_f32 v83, v126, v127
    v_fmamk_f32 v4, v79, 0x41800000, v112
    v_fmamk_f32 v5, v79, 0x41880000, v112
    v_fmamk_f32 v6, v79, 0x41900000, v112
    v_fmamk_f32 v7, v79, 0x41980000, v112
    v_fmamk_f32 v8, v79, 0x41a00000, v112
    v_fmamk_f32 v9, v79, 0x41a80000, v112
    v_fmamk_f32 v10, v79, 0x41b00000, v112
    v_fmamk_f32 v11, v79, 0x41b80000, v112
    v_cos_f32 v128, v4
    v_cos_f32 v129, v5
    v_cos_f32 v130, v6
    v_cos_f32 v131, v7
    v_cos_f32 v132, v8
    v_cos_f32 v133, v9
    v_cos_f32 v134, v10
    v_cos_f32 v135, v11
    v_add_f32 v136, v136, v136
    v_cvt_pk_bf16_f32 v84, v128, v129
    v_cvt_pk_bf16_f32 v85, v130, v131
    v_cvt_pk_bf16_f32 v86, v132, v133
    v_cvt_pk_bf16_f32 v87, v134, v135
    v_pk_fma_f32 v[120:121], v[128:129], v[136:137], v[120:121] op_sel_hi:[1,0,1] neg_lo:[0,0,1] neg_hi:[0,0,1]
    v_pk_fma_f32 v[122:123], v[130:131], v[136:137], v[122:123] op_sel_hi:[1,0,1] neg_lo:[0,0,1] neg_hi:[0,0,1]
    v_pk_fma_f32 v[124:125], v[132:133], v[136:137], v[124:125] op_sel_hi:[1,0,1] neg_lo:[0,0,1] neg_hi:[0,0,1]
    v_pk_fma_f32 v[126:127], v[134:135], v[136:137], v[126:127] op_sel_hi:[1,0,1] neg_lo:[0,0,1] neg_hi:[0,0,1]
    v_cvt_pk_bf16_f32 v88, v120, v121
    v_cvt_pk_bf16_f32 v89, v122, v123
    v_cvt_pk_bf16_f32 v90, v124, v125
    v_cvt_pk_bf16_f32 v91, v126, v127
    v_pk_fma_f32 v[128:129], v[120:121], v[136:137], v[128:129] op_sel_hi:[1,0,1] neg_lo:[0,0,1] neg_hi:[0,0,1]
    v_pk_fma_f32 v[130:131], v[122:123], v[136:137], v[130:131] op_sel_hi:[1,0,1] neg_lo:[0,0,1] neg_hi:[0,0,1]
    v_pk_fma_f32 v[132:133], v[124:125], v[136:137], v[132:133] op_sel_hi:[1,0,1] neg_lo:[0,0,1] neg_hi:[0,0,1]
    v_pk_fma_f32 v[134:135], v[126:127], v[136:137], v[134:135] op_sel_hi:[1,0,1] neg_lo:[0,0,1] neg_hi:[0,0,1]
    v_cvt_pk_bf16_f32 v92, v128, v129
    v_cvt_pk_bf16_f32 v93, v130, v131
    v_cvt_pk_bf16_f32 v94, v132, v133
    v_cvt_pk_bf16_f32 v95, v134, v135
    v_pk_fma_f32 v[120:121], v[128:129], v[136:137], v[120:121] op_sel_hi:[1,0,1] neg_lo:[0,0,1] neg_hi:[0,0,1]
    v_pk_fma_f32 v[122:123], v[130:131], v[136:137], v[122:123] op_sel_hi:[1,0,1] neg_lo:[0,0,1] neg_hi:[0,0,1]
    v_pk_fma_f32 v[124:125], v[132:133], v[136:137], v[124:125] op_sel_hi:[1,0,1] neg_lo:[0,0,1] neg_hi:[0,0,1]
    v_pk_fma_f32 v[126:127], v[134:135], v[136:137], v[126:127] op_sel_hi:[1,0,1] neg_lo:[0,0,1] neg_hi:[0,0,1]
    v_cvt_pk_bf16_f32 v96, v120, v121
    v_cvt_pk_bf16_f32 v97, v122, v123
    v_cvt_pk_bf16_f32 v98, v124, v125
    v_cvt_pk_bf16_f32 v99, v126, v127
    v_pk_fma_f32 v[128:129], v[120:121], v[136:137], v[128:129] op_sel_hi:[1,0,1] neg_lo:[0,0,1] neg_hi:[0,0,1]
    v_pk_fma_f32 v[130:131], v[122:123], v[136:137], v[130:131] op_sel_hi:[1,0,1] neg_lo:[0,0,1] neg_hi:[0,0,1]
    v_pk_fma_f32 v[132:133], v[124:125], v[136:137], v[132:133] op_sel_hi:[1,0,1] neg_lo:[0,0,1] neg_hi:[0,0,1]
    v_pk_fma_f32 v[134:135], v[126:127], v[136:137], v[134:135] op_sel_hi:[1,0,1] neg_lo:[0,0,1] neg_hi:[0,0,1]
    v_cvt_pk_bf16_f32 v100, v128, v129
    v_cvt_pk_bf16_f32 v101, v130, v131
    v_cvt_pk_bf16_f32 v102, v132, v133
    v_cvt_pk_bf16_f32 v103, v134, v135
    v_pk_fma_f32 v[120:121], v[128:129], v[136:137], v[120:121] op_sel_hi:[1,0,1] neg_lo:[0,0,1] neg_hi:[0,0,1]
    v_pk_fma_f32 v[122:123], v[130:131], v[136:137], v[122:123] op_sel_hi:[1,0,1] neg_lo:[0,0,1] neg_hi:[0,0,1]
    v_pk_fma_f32 v[124:125], v[132:133], v[136:137], v[124:125] op_sel_hi:[1,0,1] neg_lo:[0,0,1] neg_hi:[0,0,1]
    v_pk_fma_f32 v[126:127], v[134:135], v[136:137], v[126:127] op_sel_hi:[1,0,1] neg_lo:[0,0,1] neg_hi:[0,0,1]
    v_cvt_pk_bf16_f32 v104, v120, v121
    v_cvt_pk_bf16_f32 v105, v122, v123
    v_cvt_pk_bf16_f32 v106, v124, v125
    v_cvt_pk_bf16_f32 v107, v126, v127
    v_pk_fma_f32 v[128:129], v[120:121], v[136:137], v[128:129] op_sel_hi:[1,0,1] neg_lo:[0,0,1] neg_hi:[0,0,1]
    v_pk_fma_f32 v[130:131], v[122:123], v[136:137], v[130:131] op_sel_hi:[1,0,1] neg_lo:[0,0,1] neg_hi:[0,0,1]
    v_pk_fma_f32 v[132:133], v[124:125], v[136:137], v[132:133] op_sel_hi:[1,0,1] neg_lo:[0,0,1] neg_hi:[0,0,1]
    v_pk_fma_f32 v[134:135], v[126:127], v[136:137], v[134:135] op_sel_hi:[1,0,1] neg_lo:[0,0,1] neg_hi:[0,0,1]
    v_cvt_pk_bf16_f32 v108, v128, v129
    v_cvt_pk_bf16_f32 v109, v130, v131
    v_cvt_pk_bf16_f32 v110, v132, v133
    v_cvt_pk_bf16_f32 v111, v134, v135
    v_mov_b32 v216, 0
    v_mov_b32 v217, 0
    v_mov_b32 v218, 0
    v_mov_b32 v219, 0
    v_lshlrev_b32 v79, 7, v34
    s_lshl2_add_u32 s81, s52, s48
    s_mul_i32 s81, s81, 4096
    s_load_dword s61, s[24:25], s81 offset:384
    s_load_dword s61, s[24:25], s81 offset:448
    s_load_dword s61, s[24:25], s81 offset:1408
    s_load_dword s61, s[24:25], s81 offset:1472
    s_load_dword s61, s[24:25], s81 offset:2432
    s_load_dword s61, s[24:25], s81 offset:2496
    s_load_dword s61, s[24:25], s81 offset:3456
    s_load_dword s61, s[24:25], s81 offset:3520
    s_waitcnt vmcnt(7)
    s_barrier
    ds_read_b128 v[208:211], v56 offset:0
    ds_read_b128 v[212:215], v57 offset:0
    s_add_u32 m0, s64, 0x14000
    s_lshl_b32 s65, s74, 9
    buffer_load_dwordx4 v50, s[8:11], s65 offen lds
    ds_read_b128 a[0:3], v52 offset:0
    ds_read_b64_tr_b16 a[128:129], v58 offset:0
    ds_read_b64_tr_b16 a[130:131], v58 offset:512
    s_add_u32 m0, s64, 0x14400
    s_lshl_b32 s65, s74, 9
    buffer_load_dwordx4 v51, s[8:11], s65 offen lds
    ds_read_b128 a[4:7], v53 offset:0
    ds_read_b64_tr_b16 a[132:133], v58 offset:2048
    ds_read_b64_tr_b16 a[134:135], v58 offset:2560
    ds_read_b128 a[8:11], v54 offset:0
    ds_read_b64_tr_b16 a[136:137], v58 offset:4096
    ds_read_b64_tr_b16 a[138:139], v58 offset:4608
    ds_read_b128 a[12:15], v55 offset:0
    ds_read_b64_tr_b16 a[140:141], v58 offset:6144
    ds_read_b64_tr_b16 a[142:143], v58 offset:6656
    s_waitcnt lgkmcnt(12)
    v_dot2c_f32_bf16 v216, v2, v208
    v_dot2c_f32_bf16 v218, v208, v208
    v_dot2c_f32_bf16 v217, v2, v209
    v_dot2c_f32_bf16 v219, v209, v209
    v_dot2c_f32_bf16 v216, v2, v210
    v_dot2c_f32_bf16 v218, v210, v210
    v_dot2c_f32_bf16 v217, v2, v211
    v_dot2c_f32_bf16 v219, v211, v211
    v_dot2c_f32_bf16 v216, v2, v212
    v_dot2c_f32_bf16 v218, v212, v212
    v_dot2c_f32_bf16 v217, v2, v213
    v_dot2c_f32_bf16 v219, v213, v213
    v_dot2c_f32_bf16 v216, v2, v214
    v_dot2c_f32_bf16 v218, v214, v214
    v_dot2c_f32_bf16 v217, v2, v215
    v_dot2c_f32_bf16 v219, v215, v215
    ds_read_b128 v[208:211], v56 offset:8192
    ds_read_b128 v[212:215], v57 offset:8192
    s_add_u32 m0, s64, 0x8000
    s_nop 0
    buffer_load_dwordx4 v46, s[4:7], s76 offen lds
    s_add_u32 m0, s64, 0x8400
    s_nop 0
    buffer_load_dwordx4 v47, s[4:7], s76 offen lds
    s_add_u32 m0, s64, 0x16000
    s_lshl_b32 s65, s75, 9
    buffer_load_dwordx4 v50, s[8:11], s65 offen lds
    s_add_u32 m0, s64, 0x16400
    s_lshl_b32 s65, s75, 9
    buffer_load_dwordx4 v51, s[8:11], s65 offen lds
    s_waitcnt lgkmcnt(0)
    v_dot2c_f32_bf16 v216, v2, v208
    v_dot2c_f32_bf16 v218, v208, v208
    v_dot2c_f32_bf16 v217, v2, v209
    v_dot2c_f32_bf16 v219, v209, v209
    v_dot2c_f32_bf16 v216, v2, v210
    v_dot2c_f32_bf16 v218, v210, v210
    v_dot2c_f32_bf16 v217, v2, v211
    v_dot2c_f32_bf16 v219, v211, v211
    v_dot2c_f32_bf16 v216, v2, v212
    v_dot2c_f32_bf16 v218, v212, v212
    v_dot2c_f32_bf16 v217, v2, v213
    v_dot2c_f32_bf16 v219, v213, v213
    v_dot2c_f32_bf16 v216, v2, v214
    v_dot2c_f32_bf16 v218, v214, v214
    v_dot2c_f32_bf16 v217, v2, v215
    v_dot2c_f32_bf16 v219, v215, v215
    s_waitcnt vmcnt(9)
    s_barrier
    ds_read_b128 v[208:211], v56 offset:16384
    ds_read_b128 v[212:215], v57 offset:16384
    s_add_u32 m0, s64, 0xa000
    s_nop 0
    buffer_load_dwordx4 v46, s[4:7], s77 offen lds
    v_mfma_f32_32x32x16_bf16 v[120:135], a[128:131], a[0:3], 0
    ds_read_b128 a[16:19], v52 offset:8192
    v_mfma_f32_32x32x16_bf16 v[144:159], a[0:3], v[80:83], 0
    s_add_u32 m0, s64, 0xa400
    s_nop 0
    buffer_load_dwordx4 v47, s[4:7], s77 offen lds
    ds_read_b64_tr_b16 a[144:145], v58 offset:8192
    v_mfma_f32_32x32x16_bf16 v[120:135], a[132:135], a[4:7], v[120:135]
    v_mfma_f32_32x32x16_bf16 v[144:159], a[4:7], v[84:87], v[144:159]
    s_add_u32 m0, s64, 0x18000
    s_lshl_b32 s65, s76, 9
    buffer_load_dwordx4 v50, s[8:11], s65 offen lds
    ds_read_b64_tr_b16 a[146:147], v58 offset:8704
    v_mfma_f32_32x32x16_bf16 v[120:135], a[136:139], a[8:11], v[120:135]
    ds_read_b128 a[20:23], v53 offset:8192
    v_mfma_f32_32x32x16_bf16 v[144:159], a[8:11], v[88:91], v[144:159]
    s_add_u32 m0, s64, 0x18400
    s_lshl_b32 s65, s76, 9
    buffer_load_dwordx4 v51, s[8:11], s65 offen lds
    ds_read_b64_tr_b16 a[148:149], v58 offset:10240
    v_mfma_f32_32x32x16_bf16 v[120:135], a[140:143], a[12:15], v[120:135]
    ds_read_b64_tr_b16 a[150:151], v58 offset:10752
    v_mfma_f32_32x32x16_bf16 v[144:159], a[12:15], v[92:95], v[144:159]
    s_add_u32 m0, s64, 0xc000
    s_nop 0
    buffer_load_dwordx4 v46, s[4:7], s78 offen lds
    v_mfma_f32_4x4x4_16b_bf16 v[136:139], v[2:3], a[128:129], 0
    ds_read_b128 a[24:27], v54 offset:8192
    v_mfma_f32_4x4x4_16b_bf16 v[140:143], v[2:3], a[130:131], 0
    s_add_u32 m0, s64, 0xc400
    s_nop 0
    buffer_load_dwordx4 v47, s[4:7], s78 offen lds
    ds_read_b64_tr_b16 a[152:153], v58 offset:12288
    v_mfma_f32_4x4x4_16b_bf16 v[136:139], v[2:3], a[132:133], v[136:139]
    ds_read_b64_tr_b16 a[154:155], v58 offset:12800
    v_mfma_f32_4x4x4_16b_bf16 v[140:143], v[2:3], a[134:135], v[140:143]
    ds_read_b128 a[28:31], v55 offset:8192
    v_mfma_f32_4x4x4_16b_bf16 v[136:139], v[2:3], a[136:137], v[136:139]
    v_mfma_f32_4x4x4_16b_bf16 v[140:143], v[2:3], a[138:139], v[140:143]
    ds_read_b64_tr_b16 a[156:157], v58 offset:14336
    v_mfma_f32_4x4x4_16b_bf16 v[136:139], v[2:3], a[140:141], v[136:139]
    ds_read_b64_tr_b16 a[158:159], v58 offset:14848
    v_mfma_f32_4x4x4_16b_bf16 v[140:143], v[2:3], a[142:143], v[140:143]
    s_waitcnt lgkmcnt(12)
    v_dot2c_f32_bf16 v216, v2, v208
    v_dot2c_f32_bf16 v218, v208, v208
    v_dot2c_f32_bf16 v217, v2, v209
    v_dot2c_f32_bf16 v219, v209, v209
    v_dot2c_f32_bf16 v216, v2, v210
    v_dot2c_f32_bf16 v218, v210, v210
    v_dot2c_f32_bf16 v217, v2, v211
    v_dot2c_f32_bf16 v219, v211, v211
    v_dot2c_f32_bf16 v216, v2, v212
    v_dot2c_f32_bf16 v218, v212, v212
    v_dot2c_f32_bf16 v217, v2, v213
    v_dot2c_f32_bf16 v219, v213, v213
    v_dot2c_f32_bf16 v216, v2, v214
    v_dot2c_f32_bf16 v218, v214, v214
    v_dot2c_f32_bf16 v217, v2, v215
    v_dot2c_f32_bf16 v219, v215, v215
    s_waitcnt vmcnt(12)
    s_cmp_lt_u32 s71, 12
    s_cbranch_scc0 L_nordy
    s_atomic_add s80, s[40:41], 0
L_nordy:
    s_waitcnt vmcnt(10)
    s_barrier
    ds_read_b128 v[208:211], v56 offset:24576
    ds_read_b128 v[212:215], v57 offset:24576
    s_add_u32 m0, s64, 0x1a000
    s_lshl_b32 s65, s77, 9
    buffer_load_dwordx4 v50, s[8:11], s65 offen lds
    s_waitcnt lgkmcnt(11)
    v_mfma_f32_32x32x16_bf16 v[120:135], a[144:147], a[16:19], v[120:135]
    ds_read_b128 a[32:35], v52 offset:16384
    v_mfma_f32_32x32x16_bf16 v[144:159], a[16:19], v[96:99], v[144:159]
    s_add_u32 m0, s64, 0x1a400
    s_lshl_b32 s65, s77, 9
    buffer_load_dwordx4 v51, s[8:11], s65 offen lds
    s_waitcnt lgkmcnt(9)
    ds_read_b64_tr_b16 a[128:129], v58 offset:16384
    v_mfma_f32_32x32x16_bf16 v[120:135], a[148:151], a[20:23], v[120:135]
    v_mfma_f32_32x32x16_bf16 v[144:159], a[20:23], v[100:103], v[144:159]
    s_add_u32 m0, s64, 0xe000
    s_nop 0
    buffer_load_dwordx4 v46, s[4:7], s79 offen lds
    s_waitcnt lgkmcnt(7)
    ds_read_b64_tr_b16 a[130:131], v58 offset:16896
    v_mfma_f32_32x32x16_bf16 v[120:135], a[152:155], a[24:27], v[120:135]
    ds_read_b128 a[36:39], v53 offset:16384
    v_mfma_f32_32x32x16_bf16 v[144:159], a[24:27], v[104:107], v[144:159]
    s_add_u32 m0, s64, 0xe400
    s_nop 0
    buffer_load_dwordx4 v47, s[4:7], s79 offen lds
    s_waitcnt lgkmcnt(6)
    ds_read_b64_tr_b16 a[132:133], v58 offset:18432
    v_mfma_f32_32x32x16_bf16 v[120:135], a[156:159], a[28:31], v[120:135]
    ds_read_b64_tr_b16 a[134:135], v58 offset:18944
    v_mfma_f32_32x32x16_bf16 v[144:159], a[28:31], v[108:111], v[144:159]
    v_mfma_f32_4x4x4_16b_bf16 v[136:139], v[2:3], a[144:145], v[136:139]
    ds_read_b128 a[40:43], v54 offset:16384
    v_mfma_f32_4x4x4_16b_bf16 v[140:143], v[2:3], a[146:147], v[140:143]
    ds_read_b64_tr_b16 a[136:137], v58 offset:20480
    v_mfma_f32_4x4x4_16b_bf16 v[136:139], v[2:3], a[148:149], v[136:139]
    ds_read_b64_tr_b16 a[138:139], v58 offset:20992
    v_mfma_f32_4x4x4_16b_bf16 v[140:143], v[2:3], a[150:151], v[140:143]
    ds_read_b128 a[44:47], v55 offset:16384
    v_mfma_f32_4x4x4_16b_bf16 v[136:139], v[2:3], a[152:153], v[136:139]
    v_mfma_f32_4x4x4_16b_bf16 v[140:143], v[2:3], a[154:155], v[140:143]
    ds_read_b64_tr_b16 a[140:141], v58 offset:22528
    v_mfma_f32_4x4x4_16b_bf16 v[136:139], v[2:3], a[156:157], v[136:139]
    ds_read_b64_tr_b16 a[142:143], v58 offset:23040
    v_mfma_f32_4x4x4_16b_bf16 v[140:143], v[2:3], a[158:159], v[140:143]
    s_waitcnt lgkmcnt(12)
    v_dot2c_f32_bf16 v216, v2, v208
    v_dot2c_f32_bf16 v218, v208, v208
    v_dot2c_f32_bf16 v217, v2, v209
    v_dot2c_f32_bf16 v219, v209, v209
    v_dot2c_f32_bf16 v216, v2, v210
    v_dot2c_f32_bf16 v218, v210, v210
    v_dot2c_f32_bf16 v217, v2, v211
    v_dot2c_f32_bf16 v219, v211, v211
    v_dot2c_f32_bf16 v216, v2, v212
    v_dot2c_f32_bf16 v218, v212, v212
    v_dot2c_f32_bf16 v217, v2, v213
    v_dot2c_f32_bf16 v219, v213, v213
    v_dot2c_f32_bf16 v216, v2, v214
    v_dot2c_f32_bf16 v218, v214, v214
    v_dot2c_f32_bf16 v217, v2, v215
    v_dot2c_f32_bf16 v219, v215, v215
    s_waitcnt vmcnt(10)
    s_barrier
    ds_read_b128 v[208:211], v56 offset:32768
    ds_read_b128 v[212:215], v57 offset:32768
    s_add_u32 m0, s64, 0x1c000
    s_lshl_b32 s65, s78, 9
    buffer_load_dwordx4 v50, s[8:11], s65 offen lds
    s_waitcnt lgkmcnt(11)
    v_mfma_f32_32x32x16_bf16 v[120:135], a[128:131], a[32:35], v[120:135]
    ds_read_b128 a[48:51], v52 offset:24576
    v_mfma_f32_32x32x16_bf16 v[160:175], a[32:35], v[80:83], 0
    s_add_u32 m0, s64, 0x1c400
    s_lshl_b32 s65, s78, 9
    buffer_load_dwordx4 v51, s[8:11], s65 offen lds
    s_waitcnt lgkmcnt(9)
    ds_read_b64_tr_b16 a[144:145], v58 offset:24576
    v_mfma_f32_32x32x16_bf16 v[120:135], a[132:135], a[36:39], v[120:135]
    v_mfma_f32_32x32x16_bf16 v[160:175], a[36:39], v[84:87], v[160:175]
    s_add_u32 m0, s64, 0x1e000
    s_lshl_b32 s65, s79, 9
    buffer_load_dwordx4 v50, s[8:11], s65 offen lds
    s_waitcnt lgkmcnt(7)
    ds_read_b64_tr_b16 a[146:147], v58 offset:25088
    v_mfma_f32_32x32x16_bf16 v[120:135], a[136:139], a[40:43], v[120:135]
    ds_read_b128 a[52:55], v53 offset:24576
    v_mfma_f32_32x32x16_bf16 v[160:175], a[40:43], v[88:91], v[160:175]
    s_add_u32 m0, s64, 0x1e400
    s_lshl_b32 s65, s79, 9
    buffer_load_dwordx4 v51, s[8:11], s65 offen lds
    s_waitcnt lgkmcnt(6)
    ds_read_b64_tr_b16 a[148:149], v58 offset:26624
    v_mfma_f32_32x32x16_bf16 v[120:135], a[140:143], a[44:47], v[120:135]
    ds_read_b64_tr_b16 a[150:151], v58 offset:27136
    v_mfma_f32_32x32x16_bf16 v[160:175], a[44:47], v[92:95], v[160:175]
    s_add_u32 m0, s64, 0x22000
    s_nop 0
    buffer_load_dwordx4 v65, s[16:19], 0 offen lds
    v_mfma_f32_4x4x4_16b_bf16 v[136:139], v[2:3], a[128:129], v[136:139]
    ds_read_b128 a[56:59], v54 offset:24576
    v_mfma_f32_4x4x4_16b_bf16 v[140:143], v[2:3], a[130:131], v[140:143]
    s_add_u32 m0, s64, 0x22400
    s_nop 0
    buffer_load_dwordx4 v65, s[20:23], 0 offen lds
    ds_read_b64_tr_b16 a[152:153], v58 offset:28672
    v_mfma_f32_4x4x4_16b_bf16 v[136:139], v[2:3], a[132:133], v[136:139]
    ds_read_b64_tr_b16 a[154:155], v58 offset:29184
    v_mfma_f32_4x4x4_16b_bf16 v[140:143], v[2:3], a[134:135], v[140:143]
    ds_read_b128 a[60:63], v55 offset:24576
    v_mfma_f32_4x4x4_16b_bf16 v[136:139], v[2:3], a[136:137], v[136:139]
    v_mfma_f32_4x4x4_16b_bf16 v[140:143], v[2:3], a[138:139], v[140:143]
    ds_read_b64_tr_b16 a[156:157], v58 offset:30720
    v_mfma_f32_4x4x4_16b_bf16 v[136:139], v[2:3], a[140:141], v[136:139]
    ds_read_b64_tr_b16 a[158:159], v58 offset:31232
    v_mfma_f32_4x4x4_16b_bf16 v[140:143], v[2:3], a[142:143], v[140:143]
    s_waitcnt lgkmcnt(12)
    v_dot2c_f32_bf16 v216, v2, v208
    v_dot2c_f32_bf16 v218, v208, v208
    v_dot2c_f32_bf16 v217, v2, v209
    v_dot2c_f32_bf16 v219, v209, v209
    v_dot2c_f32_bf16 v216, v2, v210
    v_dot2c_f32_bf16 v218, v210, v210
    v_dot2c_f32_bf16 v217, v2, v211
    v_dot2c_f32_bf16 v219, v211, v211
    v_dot2c_f32_bf16 v216, v2, v212
    v_dot2c_f32_bf16 v218, v212, v212
    v_dot2c_f32_bf16 v217, v2, v213
    v_dot2c_f32_bf16 v219, v213, v213
    v_dot2c_f32_bf16 v216, v2, v214
    v_dot2c_f32_bf16 v218, v214, v214
    v_dot2c_f32_bf16 v217, v2, v215
    v_dot2c_f32_bf16 v219, v215, v215
    s_waitcnt vmcnt(12)
    s_barrier
    ds_read_b128 v[208:211], v56 offset:40960
    ds_read_b128 v[212:215], v57 offset:40960
    s_add_u32 m0, s64, 0x20000
    s_mov_b32 s65, 0
    buffer_load_dwordx4 v64, s[32:35], s65 offen lds
    s_waitcnt lgkmcnt(11)
    v_mfma_f32_32x32x16_bf16 v[120:135], a[144:147], a[48:51], v[120:135]
    ds_read_b128 a[64:67], v52 offset:32768
    v_mfma_f32_32x32x16_bf16 v[160:175], a[48:51], v[96:99], v[160:175]
    s_add_u32 m0, s64, 0x20400
    s_mov_b32 s65, 8192
    buffer_load_dwordx4 v64, s[32:35], s65 offen lds
    s_waitcnt lgkmcnt(9)
    ds_read_b64_tr_b16 a[128:129], v58 offset:32768
    v_mfma_f32_32x32x16_bf16 v[120:135], a[148:151], a[52:55], v[120:135]
    v_mfma_f32_32x32x16_bf16 v[160:175], a[52:55], v[100:103], v[160:175]
    s_add_u32 m0, s64, 0x10000
    s_nop 0
    buffer_load_dwordx4 v48, s[4:7], 0 offen lds
    s_waitcnt lgkmcnt(7)
    ds_read_b64_tr_b16 a[130:131], v58 offset:33280
    v_mfma_f32_32x32x16_bf16 v[120:135], a[152:155], a[56:59], v[120:135]
    ds_read_b128 a[68:71], v53 offset:32768
    v_mfma_f32_32x32x16_bf16 v[160:175], a[56:59], v[104:107], v[160:175]
    s_add_u32 m0, s64, 0x10400
    s_nop 0
    buffer_load_dwordx4 v49, s[4:7], 0 offen lds
    s_waitcnt lgkmcnt(6)
    ds_read_b64_tr_b16 a[132:133], v58 offset:34816
    v_mfma_f32_32x32x16_bf16 v[120:135], a[156:159], a[60:63], v[120:135]
    ds_read_b64_tr_b16 a[134:135], v58 offset:35328
    v_mfma_f32_32x32x16_bf16 v[160:175], a[60:63], v[108:111], v[160:175]
    v_mfma_f32_4x4x4_16b_bf16 v[136:139], v[2:3], a[144:145], v[136:139]
    ds_read_b128 a[72:75], v54 offset:32768
    v_mfma_f32_4x4x4_16b_bf16 v[140:143], v[2:3], a[146:147], v[140:143]
    ds_read_b64_tr_b16 a[136:137], v58 offset:36864
    v_mfma_f32_4x4x4_16b_bf16 v[136:139], v[2:3], a[148:149], v[136:139]
    ds_read_b64_tr_b16 a[138:139], v58 offset:37376
    v_mfma_f32_4x4x4_16b_bf16 v[140:143], v[2:3], a[150:151], v[140:143]
    ds_read_b128 a[76:79], v55 offset:32768
    v_mfma_f32_4x4x4_16b_bf16 v[136:139], v[2:3], a[152:153], v[136:139]
    v_mfma_f32_4x4x4_16b_bf16 v[140:143], v[2:3], a[154:155], v[140:143]
    ds_read_b64_tr_b16 a[140:141], v58 offset:38912
    v_mfma_f32_4x4x4_16b_bf16 v[136:139], v[2:3], a[156:157], v[136:139]
    ds_read_b64_tr_b16 a[142:143], v58 offset:39424
    v_mfma_f32_4x4x4_16b_bf16 v[140:143], v[2:3], a[158:159], v[140:143]
    s_waitcnt lgkmcnt(12)
    v_dot2c_f32_bf16 v216, v2, v208
    v_dot2c_f32_bf16 v218, v208, v208
    v_dot2c_f32_bf16 v217, v2, v209
    v_dot2c_f32_bf16 v219, v209, v209
    v_dot2c_f32_bf16 v216, v2, v210
    v_dot2c_f32_bf16 v218, v210, v210
    v_dot2c_f32_bf16 v217, v2, v211
    v_dot2c_f32_bf16 v219, v211, v211
    v_dot2c_f32_bf16 v216, v2, v212
    v_dot2c_f32_bf16 v218, v212, v212
    v_dot2c_f32_bf16 v217, v2, v213
    v_dot2c_f32_bf16 v219, v213, v213
    v_dot2c_f32_bf16 v216, v2, v214
    v_dot2c_f32_bf16 v218, v214, v214
    v_dot2c_f32_bf16 v217, v2, v215
    v_dot2c_f32_bf16 v219, v215, v215
    s_waitcnt vmcnt(12)
    s_barrier
    ds_read_b128 v[208:211], v56 offset:49152
    ds_read_b128 v[212:215], v57 offset:49152
    s_add_u32 m0, s64, 0x0
    s_lshl_b32 s65, s72, 9
    buffer_load_dwordx4 v50, s[24:27], s65 offen lds
    s_waitcnt lgkmcnt(11)
    v_mfma_f32_32x32x16_bf16 v[120:135], a[128:131], a[64:67], v[120:135]
    ds_read_b128 a[80:83], v52 offset:40960
    v_mfma_f32_32x32x16_bf16 v[176:191], a[64:67], v[80:83], 0
    s_add_u32 m0, s64, 0x400
    s_lshl_b32 s65, s72, 9
    buffer_load_dwordx4 v51, s[24:27], s65 offen lds
    s_waitcnt lgkmcnt(9)
    ds_read_b64_tr_b16 a[144:145], v58 offset:40960
    v_mfma_f32_32x32x16_bf16 v[120:135], a[132:135], a[68:71], v[120:135]
    v_mfma_f32_32x32x16_bf16 v[176:191], a[68:71], v[84:87], v[176:191]
    s_waitcnt lgkmcnt(7)
    ds_read_b64_tr_b16 a[146:147], v58 offset:41472
    v_mfma_f32_32x32x16_bf16 v[120:135], a[136:139], a[72:75], v[120:135]
    ds_read_b128 a[84:87], v53 offset:40960
    v_mfma_f32_32x32x16_bf16 v[176:191], a[72:75], v[88:91], v[176:191]
    s_waitcnt lgkmcnt(6)
    ds_read_b64_tr_b16 a[148:149], v58 offset:43008
    v_mfma_f32_32x32x16_bf16 v[120:135], a[140:143], a[76:79], v[120:135]
    ds_read_b64_tr_b16 a[150:151], v58 offset:43520
    v_mfma_f32_32x32x16_bf16 v[176:191], a[76:79], v[92:95], v[176:191]
    v_mfma_f32_4x4x4_16b_bf16 v[136:139], v[2:3], a[128:129], v[136:139]
    ds_read_b128 a[88:91], v54 offset:40960
    v_mfma_f32_4x4x4_16b_bf16 v[140:143], v[2:3], a[130:131], v[140:143]
    ds_read_b64_tr_b16 a[152:153], v58 offset:45056
    v_mfma_f32_4x4x4_16b_bf16 v[136:139], v[2:3], a[132:133], v[136:139]
    ds_read_b64_tr_b16 a[154:155], v58 offset:45568
    v_mfma_f32_4x4x4_16b_bf16 v[140:143], v[2:3], a[134:135], v[140:143]
    ds_read_b128 a[92:95], v55 offset:40960
    v_mfma_f32_4x4x4_16b_bf16 v[136:139], v[2:3], a[136:137], v[136:139]
    v_mfma_f32_4x4x4_16b_bf16 v[140:143], v[2:3], a[138:139], v[140:143]
    ds_read_b64_tr_b16 a[156:157], v58 offset:47104
    v_mfma_f32_4x4x4_16b_bf16 v[136:139], v[2:3], a[140:141], v[136:139]
    ds_read_b64_tr_b16 a[158:159], v58 offset:47616
    v_mfma_f32_4x4x4_16b_bf16 v[140:143], v[2:3], a[142:143], v[140:143]
    s_waitcnt lgkmcnt(12)
    v_dot2c_f32_bf16 v216, v2, v208
    v_dot2c_f32_bf16 v218, v208, v208
    v_dot2c_f32_bf16 v217, v2, v209
    v_dot2c_f32_bf16 v219, v209, v209
    v_dot2c_f32_bf16 v216, v2, v210
    v_dot2c_f32_bf16 v218, v210, v210
    v_dot2c_f32_bf16 v217, v2, v211
    v_dot2c_f32_bf16 v219, v211, v211
    v_dot2c_f32_bf16 v216, v2, v212
    v_dot2c_f32_bf16 v218, v212, v212
    v_dot2c_f32_bf16 v217, v2, v213
    v_dot2c_f32_bf16 v219, v213, v213
    v_dot2c_f32_bf16 v216, v2, v214
    v_dot2c_f32_bf16 v218, v214, v214
    v_dot2c_f32_bf16 v217, v2, v215
    v_dot2c_f32_bf16 v219, v215, v215
    s_waitcnt vmcnt(10)
    s_barrier
    ds_read_b128 v[208:211], v56 offset:57344
    ds_read_b128 v[212:215], v57 offset:57344
    s_add_u32 m0, s64, 0x2000
    s_lshl_b32 s65, s73, 9
    buffer_load_dwordx4 v50, s[24:27], s65 offen lds
    s_waitcnt lgkmcnt(11)
    v_mfma_f32_32x32x16_bf16 v[120:135], a[144:147], a[80:83], v[120:135]
    ds_read_b128 a[96:99], v52 offset:49152
    v_mfma_f32_32x32x16_bf16 v[176:191], a[80:83], v[96:99], v[176:191]
    s_add_u32 m0, s64, 0x2400
    s_lshl_b32 s65, s73, 9
    buffer_load_dwordx4 v51, s[24:27], s65 offen lds
    s_waitcnt lgkmcnt(9)
    ds_read_b64_tr_b16 a[128:129], v58 offset:49152
    v_mfma_f32_32x32x16_bf16 v[120:135], a[148:151], a[84:87], v[120:135]
    v_mfma_f32_32x32x16_bf16 v[176:191], a[84:87], v[100:103], v[176:191]
    s_waitcnt lgkmcnt(7)
    ds_read_b64_tr_b16 a[130:131], v58 offset:49664
    v_mfma_f32_32x32x16_bf16 v[120:135], a[152:155], a[88:91], v[120:135]
    ds_read_b128 a[100:103], v53 offset:49152
    v_mfma_f32_32x32x16_bf16 v[176:191], a[88:91], v[104:107], v[176:191]
    s_waitcnt lgkmcnt(6)
    ds_read_b64_tr_b16 a[132:133], v58 offset:51200
    v_mfma_f32_32x32x16_bf16 v[120:135], a[156:159], a[92:95], v[120:135]
    ds_read_b64_tr_b16 a[134:135], v58 offset:51712
    v_mfma_f32_32x32x16_bf16 v[176:191], a[92:95], v[108:111], v[176:191]
    v_mfma_f32_4x4x4_16b_bf16 v[136:139], v[2:3], a[144:145], v[136:139]
    ds_read_b128 a[104:107], v54 offset:49152
    v_mfma_f32_4x4x4_16b_bf16 v[140:143], v[2:3], a[146:147], v[140:143]
    ds_read_b64_tr_b16 a[136:137], v58 offset:53248
    v_mfma_f32_4x4x4_16b_bf16 v[136:139], v[2:3], a[148:149], v[136:139]
    ds_read_b64_tr_b16 a[138:139], v58 offset:53760
    v_mfma_f32_4x4x4_16b_bf16 v[140:143], v[2:3], a[150:151], v[140:143]
    ds_read_b128 a[108:111], v55 offset:49152
    v_mfma_f32_4x4x4_16b_bf16 v[136:139], v[2:3], a[152:153], v[136:139]
    v_mfma_f32_4x4x4_16b_bf16 v[140:143], v[2:3], a[154:155], v[140:143]
    ds_read_b64_tr_b16 a[140:141], v58 offset:55296
    v_mfma_f32_4x4x4_16b_bf16 v[136:139], v[2:3], a[156:157], v[136:139]
    ds_read_b64_tr_b16 a[142:143], v58 offset:55808
    v_mfma_f32_4x4x4_16b_bf16 v[140:143], v[2:3], a[158:159], v[140:143]
    s_waitcnt lgkmcnt(12)
    v_dot2c_f32_bf16 v216, v2, v208
    v_dot2c_f32_bf16 v218, v208, v208
    v_dot2c_f32_bf16 v217, v2, v209
    v_dot2c_f32_bf16 v219, v209, v209
    v_dot2c_f32_bf16 v216, v2, v210
    v_dot2c_f32_bf16 v218, v210, v210
    v_dot2c_f32_bf16 v217, v2, v211
    v_dot2c_f32_bf16 v219, v211, v211
    v_dot2c_f32_bf16 v216, v2, v212
    v_dot2c_f32_bf16 v218, v212, v212
    v_dot2c_f32_bf16 v217, v2, v213
    v_dot2c_f32_bf16 v219, v213, v213
    v_dot2c_f32_bf16 v216, v2, v214
    v_dot2c_f32_bf16 v218, v214, v214
    v_dot2c_f32_bf16 v217, v2, v215
    v_dot2c_f32_bf16 v219, v215, v215
    s_nop 1
    v_add_f32 v216, v216, v217
    v_add_f32 v217, v218, v219
    s_lshl_b32 s56, s48, 9
    s_add_u32 s56, s56, 0x26000
    v_lshl_add_u32 v4, v34, 3, s56
    ds_write_b64 v4, v[216:217]
    s_lshl_b32 s56, s55, 8
    s_add_u32 s56, s56, 0x26000
    v_lshl_add_u32 v5, v35, 3, s56
    s_lshl_b32 s56, s49, 6
    s_lshl_b32 s59, s55, 5
    s_add_u32 s56, s56, s59
    s_sub_u32 s56, s56, s51
    s_waitcnt vmcnt(10)
    s_waitcnt lgkmcnt(0)
    s_barrier
    s_add_u32 m0, s64, 0x4000
    s_lshl_b32 s65, s74, 9
    buffer_load_dwordx4 v50, s[24:27], s65 offen lds
    v_mfma_f32_32x32x16_bf16 v[120:135], a[128:131], a[96:99], v[120:135]
    ds_read_b128 a[112:115], v52 offset:57344
    ds_read_b64_tr_b16 a[144:145], v58 offset:57344
    v_mfma_f32_32x32x16_bf16 v[192:207], a[96:99], v[80:83], 0
    s_add_u32 m0, s64, 0x4400
    s_lshl_b32 s65, s74, 9
    buffer_load_dwordx4 v51, s[24:27], s65 offen lds
    ds_read_b64_tr_b16 a[146:147], v58 offset:57856
    ds_read_b128 a[116:119], v53 offset:57344
    v_mfma_f32_32x32x16_bf16 v[120:135], a[132:135], a[100:103], v[120:135]
    ds_read_b64_tr_b16 a[148:149], v58 offset:59392
    ds_read_b64_tr_b16 a[150:151], v58 offset:59904
    v_mfma_f32_32x32x16_bf16 v[192:207], a[100:103], v[84:87], v[192:207]
    ds_read_b128 a[120:123], v54 offset:57344
    ds_read_b64_tr_b16 a[152:153], v58 offset:61440
    v_mfma_f32_32x32x16_bf16 v[120:135], a[136:139], a[104:107], v[120:135]
    ds_read_b64_tr_b16 a[154:155], v58 offset:61952
    ds_read_b128 a[124:127], v55 offset:57344
    v_mfma_f32_32x32x16_bf16 v[192:207], a[104:107], v[88:91], v[192:207]
    ds_read_b64_tr_b16 a[156:157], v58 offset:63488
    ds_read_b64_tr_b16 a[158:159], v58 offset:64000
    v_mfma_f32_32x32x16_bf16 v[120:135], a[140:143], a[108:111], v[120:135]
    ds_read_b64 v[208:209], v5 offset:0
    ds_read_b64 v[210:211], v5 offset:512
    v_mfma_f32_32x32x16_bf16 v[192:207], a[108:111], v[92:95], v[192:207]
    ds_read_b64 v[212:213], v5 offset:1024
    ds_read_b64 v[214:215], v5 offset:1536
    s_waitcnt lgkmcnt(0)
    v_mfma_f32_4x4x4_16b_bf16 v[136:139], v[2:3], a[128:129], v[136:139]
    v_add_f32 v208, v208, v210
    v_add_f32 v209, v209, v211
    v_mfma_f32_4x4x4_16b_bf16 v[140:143], v[2:3], a[130:131], v[140:143]
    v_add_f32 v212, v212, v214
    v_add_f32 v213, v213, v215
    v_mfma_f32_4x4x4_16b_bf16 v[136:139], v[2:3], a[132:133], v[136:139]
    v_add_f32 v208, v208, v212
    v_add_f32 v209, v209, v213
    v_mfma_f32_4x4x4_16b_bf16 v[140:143], v[2:3], a[134:135], v[140:143]
    v_mul_f32 v112, 0x3b000000, v208
    v_mul_f32 v209, 0x3b000000, v209
    v_mfma_f32_4x4x4_16b_bf16 v[136:139], v[2:3], a[136:137], v[136:139]
    v_fma_f32 v209, -v112, v112, v209
    v_max_f32 v209, 0, v209
    v_mfma_f32_4x4x4_16b_bf16 v[140:143], v[2:3], a[138:139], v[140:143]
    v_add_f32 v210, 0x3727c5ac, v209
    v_mfma_f32_4x4x4_16b_bf16 v[136:139], v[2:3], a[140:141], v[136:139]
    v_rsq_f32 v113, v210
    v_cvt_pk_bf16_f32 v224, -v112, -v112
    v_mfma_f32_4x4x4_16b_bf16 v[140:143], v[2:3], a[142:143], v[140:143]
    v_mfma_f32_4x4x4_16b_bf16 v[136:139], v[2:3], a[144:145], v[136:139]
    s_nop 0
    v_mfma_f32_4x4x4_16b_bf16 v[140:143], v[2:3], a[146:147], v[140:143]
    v_mfma_f32_4x4x4_16b_bf16 v[136:139], v[2:3], a[148:149], v[136:139]
    s_nop 0
    v_mfma_f32_4x4x4_16b_bf16 v[140:143], v[2:3], a[150:151], v[140:143]
    v_mfma_f32_4x4x4_16b_bf16 v[136:139], v[2:3], a[152:153], v[136:139]
    s_nop 0
    v_mfma_f32_4x4x4_16b_bf16 v[140:143], v[2:3], a[154:155], v[140:143]
    v_mfma_f32_4x4x4_16b_bf16 v[136:139], v[2:3], a[156:157], v[136:139]
    s_nop 0
    v_mfma_f32_4x4x4_16b_bf16 v[140:143], v[2:3], a[158:159], v[140:143]
    v_mfma_f32_32x32x16_bf16 v[120:135], a[144:147], a[112:115], v[120:135]
    v_mul_f32 v209, v209, v113
    v_and_b32 v213, 0xffff0000, v224
    v_mul_f32 v209, v209, v113
    v_add_f32 v213, v112, v213
    v_add_f32 v210, 0x3727c5ac, v209
    v_rsq_f32 v211, v210
    v_cvt_pk_bf16_f32 v225, -v213, -v213
    v_mov_b32 v226, 0
    v_mov_b32 v227, 0
    v_add_u32 v212, s56, v35
    v_mfma_f32_32x32x16_bf16 v[120:135], a[148:151], a[116:119], v[120:135]
    v_mul_f32 v211, v113, v211
    v_cmp_gt_u32 vcc, 0x800, v212
    v_mul_f32 v212, v211, v211
    s_nop 0
    v_cndmask_b32 v211, 0, v211, vcc
    v_mul_f32 v212, 0x3d372713, v212
    v_rcp_f32 v222, v211
    v_mul_f32 v220, 0xc0135761, v211
    v_mul_f32 v221, v220, v212
    v_add_f32 v6, v136, v140
    v_cmp_eq_u32 vcc, 0, v36
    v_mov_b32 v7, v6
    v_mfma_f32_32x32x16_bf16 v[120:135], a[152:155], a[120:123], v[120:135]
    v_mov_b32 v230, 0
    v_permlane32_swap_b32 v6, v7
    v_mov_b32 v231, 0
    v_add_f32 v6, v6, v7
    v_cvt_pk_bf16_f32 v7, v6, v6
    v_and_b32 v8, 0xffff0000, v7
    v_sub_f32 v8, v6, v8
    v_cvt_pk_bf16_f32 v8, v6, v8
    v_and_b32 v7, 0xffff, v7
    v_cndmask_b32 v228, 0, v8, vcc
    v_cndmask_b32 v229, 0, v7, vcc
    v_mfma_f32_32x32x16_bf16 v[120:135], a[156:159], a[124:127], v[120:135]
    s_nop 0
    v_mfma_f32_32x32x16_bf16 v[120:135], v[228:231], v[224:227], v[120:135]
    buffer_load_dword v40, off, s[40:43], 0 sc1
    buffer_store_dwordx2 v[112:113], v78, s[12:15], 0 offen sc1
    s_lshl_b32 s56, s48, 7
    s_add_u32 s56, s56, 0x12000
    v_lshl_add_u32 v8, v35, 2, s56
    ds_write_b32 v8, v113
    v_lshl_add_u32 v9, v36, 4, s56
    s_nop 4
    v_pk_mul_f32 v[240:241], v[120:121], v[120:121]
    v_pk_mul_f32 v[242:243], v[122:123], v[122:123]
    v_pk_mul_f32 v[244:245], v[124:125], v[124:125]
    v_pk_mul_f32 v[246:247], v[126:127], v[126:127]
    v_pk_fma_f32 v[240:241], v[240:241], v[220:221], v[220:221] op_sel:[0,1,0] op_sel_hi:[1,1,0]
    v_pk_fma_f32 v[242:243], v[242:243], v[220:221], v[220:221] op_sel:[0,1,0] op_sel_hi:[1,1,0]
    v_pk_fma_f32 v[244:245], v[244:245], v[220:221], v[220:221] op_sel:[0,1,0] op_sel_hi:[1,1,0]
    v_pk_fma_f32 v[246:247], v[246:247], v[220:221], v[220:221] op_sel:[0,1,0] op_sel_hi:[1,1,0]
    v_pk_mul_f32 v[240:241], v[240:241], v[120:121]
    v_pk_mul_f32 v[242:243], v[242:243], v[122:123]
    v_pk_mul_f32 v[244:245], v[244:245], v[124:125]
    v_pk_mul_f32 v[246:247], v[246:247], v[126:127]
    v_exp_f32 v248, v240
    v_exp_f32 v249, v241
    v_exp_f32 v250, v242
    v_exp_f32 v251, v243
    v_exp_f32 v252, v244
    v_exp_f32 v253, v245
    v_exp_f32 v254, v246
    v_exp_f32 v255, v247
    v_pk_fma_f32 v[248:249], v[248:249], v[222:223], v[222:223] op_sel_hi:[1,0,0]
    v_pk_fma_f32 v[250:251], v[250:251], v[222:223], v[222:223] op_sel_hi:[1,0,0]
    v_pk_fma_f32 v[252:253], v[252:253], v[222:223], v[222:223] op_sel_hi:[1,0,0]
    v_pk_fma_f32 v[254:255], v[254:255], v[222:223], v[222:223] op_sel_hi:[1,0,0]
    v_rcp_f32 v240, v248
    v_rcp_f32 v241, v249
    v_rcp_f32 v242, v250
    v_rcp_f32 v243, v251
    v_rcp_f32 v244, v252
    v_rcp_f32 v245, v253
    v_rcp_f32 v246, v254
    v_rcp_f32 v247, v255
    v_pk_mul_f32 v[120:121], v[120:121], v[240:241]
    v_pk_mul_f32 v[122:123], v[122:123], v[242:243]
    v_pk_mul_f32 v[124:125], v[124:125], v[244:245]
    v_pk_mul_f32 v[126:127], v[126:127], v[246:247]
    v_cvt_pk_bf16_f32 v232, v120, v121
    v_cvt_pk_bf16_f32 v233, v122, v123
    v_cvt_pk_bf16_f32 v234, v124, v125
    v_cvt_pk_bf16_f32 v235, v126, v127
    v_pk_mul_f32 v[240:241], v[128:129], v[128:129]
    v_pk_mul_f32 v[242:243], v[130:131], v[130:131]
    v_pk_mul_f32 v[244:245], v[132:133], v[132:133]
    v_pk_mul_f32 v[246:247], v[134:135], v[134:135]
    v_pk_fma_f32 v[240:241], v[240:241], v[220:221], v[220:221] op_sel:[0,1,0] op_sel_hi:[1,1,0]
    v_pk_fma_f32 v[242:243], v[242:243], v[220:221], v[220:221] op_sel:[0,1,0] op_sel_hi:[1,1,0]
    v_pk_fma_f32 v[244:245], v[244:245], v[220:221], v[220:221] op_sel:[0,1,0] op_sel_hi:[1,1,0]
    v_pk_fma_f32 v[246:247], v[246:247], v[220:221], v[220:221] op_sel:[0,1,0] op_sel_hi:[1,1,0]
    v_pk_mul_f32 v[240:241], v[240:241], v[128:129]
    v_pk_mul_f32 v[242:243], v[242:243], v[130:131]
    v_pk_mul_f32 v[244:245], v[244:245], v[132:133]
    v_pk_mul_f32 v[246:247], v[246:247], v[134:135]
    v_exp_f32 v248, v240
    v_exp_f32 v249, v241
    v_exp_f32 v250, v242
    v_exp_f32 v251, v243
    v_exp_f32 v252, v244
    v_exp_f32 v253, v245
    v_exp_f32 v254, v246
    v_exp_f32 v255, v247
    v_pk_fma_f32 v[248:249], v[248:249], v[222:223], v[222:223] op_sel_hi:[1,0,0]
    v_pk_fma_f32 v[250:251], v[250:251], v[222:223], v[222:223] op_sel_hi:[1,0,0]
    v_pk_fma_f32 v[252:253], v[252:253], v[222:223], v[222:223] op_sel_hi:[1,0,0]
    v_pk_fma_f32 v[254:255], v[254:255], v[222:223], v[222:223] op_sel_hi:[1,0,0]
    v_rcp_f32 v240, v248
    v_rcp_f32 v241, v249
    v_rcp_f32 v242, v250
    v_rcp_f32 v243, v251
    v_rcp_f32 v244, v252
    v_rcp_f32 v245, v253
    v_rcp_f32 v246, v254
    v_rcp_f32 v247, v255
    v_pk_mul_f32 v[128:129], v[128:129], v[240:241]
    v_pk_mul_f32 v[130:131], v[130:131], v[242:243]
    v_pk_mul_f32 v[132:133], v[132:133], v[244:245]
    v_pk_mul_f32 v[134:135], v[134:135], v[246:247]
    v_cvt_pk_bf16_f32 v236, v128, v129
    v_cvt_pk_bf16_f32 v237, v130, v131
    v_cvt_pk_bf16_f32 v238, v132, v133
    v_cvt_pk_bf16_f32 v239, v134, v135
    buffer_store_dwordx4 v[232:235], v30, s[12:15], s67 offen sc1
    buffer_store_dwordx4 v[236:239], v30, s[12:15], s67 offen offset:1024 sc1
    v_mfma_f32_32x32x16_bf16 v[192:207], a[112:115], v[96:99], v[192:207]
    v_mfma_f32_32x32x16_bf16 v[192:207], a[116:119], v[100:103], v[192:207]
    v_mfma_f32_32x32x16_bf16 v[192:207], a[120:123], v[104:107], v[192:207]
    v_mfma_f32_32x32x16_bf16 v[192:207], a[124:127], v[108:111], v[192:207]
    ds_read_b128 v[80:83], v9 offset:0
    ds_read_b128 v[84:87], v9 offset:32
    ds_read_b128 v[88:91], v9 offset:64
    ds_read_b128 v[92:95], v9 offset:96
    v_pk_fma_f32 v[144:145], v[176:177], v[114:115], v[144:145] op_sel_hi:[1,0,1]
    v_pk_fma_f32 v[146:147], v[178:179], v[114:115], v[146:147] op_sel_hi:[1,0,1]
    v_pk_fma_f32 v[148:149], v[180:181], v[114:115], v[148:149] op_sel_hi:[1,0,1]
    v_pk_fma_f32 v[150:151], v[182:183], v[114:115], v[150:151] op_sel_hi:[1,0,1]
    v_pk_fma_f32 v[152:153], v[184:185], v[114:115], v[152:153] op_sel_hi:[1,0,1]
    v_pk_fma_f32 v[154:155], v[186:187], v[114:115], v[154:155] op_sel_hi:[1,0,1]
    v_pk_fma_f32 v[156:157], v[188:189], v[114:115], v[156:157] op_sel_hi:[1,0,1]
    v_pk_fma_f32 v[158:159], v[190:191], v[114:115], v[158:159] op_sel_hi:[1,0,1]
    v_pk_fma_f32 v[160:161], v[192:193], v[114:115], v[160:161] op_sel_hi:[1,0,1]
    v_pk_fma_f32 v[162:163], v[194:195], v[114:115], v[162:163] op_sel_hi:[1,0,1]
    v_pk_fma_f32 v[164:165], v[196:197], v[114:115], v[164:165] op_sel_hi:[1,0,1]
    v_pk_fma_f32 v[166:167], v[198:199], v[114:115], v[166:167] op_sel_hi:[1,0,1]
    v_pk_fma_f32 v[168:169], v[200:201], v[114:115], v[168:169] op_sel_hi:[1,0,1]
    v_pk_fma_f32 v[170:171], v[202:203], v[114:115], v[170:171] op_sel_hi:[1,0,1]
    v_pk_fma_f32 v[172:173], v[204:205], v[114:115], v[172:173] op_sel_hi:[1,0,1]
    v_pk_fma_f32 v[174:175], v[206:207], v[114:115], v[174:175] op_sel_hi:[1,0,1]
    v_pk_mul_f32 v[176:177], v[144:145], v[116:117] op_sel_hi:[1,0]
    v_pk_mul_f32 v[178:179], v[146:147], v[116:117] op_sel_hi:[1,0]
    v_pk_mul_f32 v[180:181], v[148:149], v[116:117] op_sel_hi:[1,0]
    v_pk_mul_f32 v[182:183], v[150:151], v[116:117] op_sel_hi:[1,0]
    v_pk_mul_f32 v[184:185], v[152:153], v[116:117] op_sel_hi:[1,0]
    v_pk_mul_f32 v[186:187], v[154:155], v[116:117] op_sel_hi:[1,0]
    v_pk_mul_f32 v[188:189], v[156:157], v[116:117] op_sel_hi:[1,0]
    v_pk_mul_f32 v[190:191], v[158:159], v[116:117] op_sel_hi:[1,0]
    v_pk_fma_f32 v[176:177], v[160:161], v[116:117], v[176:177] op_sel:[0,1,0] op_sel_hi:[1,1,1]
    v_pk_fma_f32 v[178:179], v[162:163], v[116:117], v[178:179] op_sel:[0,1,0] op_sel_hi:[1,1,1]
    v_pk_fma_f32 v[180:181], v[164:165], v[116:117], v[180:181] op_sel:[0,1,0] op_sel_hi:[1,1,1]
    v_pk_fma_f32 v[182:183], v[166:167], v[116:117], v[182:183] op_sel:[0,1,0] op_sel_hi:[1,1,1]
    v_pk_fma_f32 v[184:185], v[168:169], v[116:117], v[184:185] op_sel:[0,1,0] op_sel_hi:[1,1,1]
    v_pk_fma_f32 v[186:187], v[170:171], v[116:117], v[186:187] op_sel:[0,1,0] op_sel_hi:[1,1,1]
    v_pk_fma_f32 v[188:189], v[172:173], v[116:117], v[188:189] op_sel:[0,1,0] op_sel_hi:[1,1,1]
    v_pk_fma_f32 v[190:191], v[174:175], v[116:117], v[190:191] op_sel:[0,1,0] op_sel_hi:[1,1,1]
    s_waitcnt lgkmcnt(0)
    v_fmac_f32_dpp v176, v144, v118 quad_perm:[1,0,3,2] row_mask:0xf bank_mask:0xf
    v_fmac_f32_dpp v177, v145, v118 quad_perm:[1,0,3,2] row_mask:0xf bank_mask:0xf
    v_fmac_f32_dpp v178, v146, v118 quad_perm:[1,0,3,2] row_mask:0xf bank_mask:0xf
    v_fmac_f32_dpp v179, v147, v118 quad_perm:[1,0,3,2] row_mask:0xf bank_mask:0xf
    v_fmac_f32_dpp v176, v160, v119 quad_perm:[1,0,3,2] row_mask:0xf bank_mask:0xf
    v_fmac_f32_dpp v177, v161, v119 quad_perm:[1,0,3,2] row_mask:0xf bank_mask:0xf
    v_fmac_f32_dpp v178, v162, v119 quad_perm:[1,0,3,2] row_mask:0xf bank_mask:0xf
    v_fmac_f32_dpp v179, v163, v119 quad_perm:[1,0,3,2] row_mask:0xf bank_mask:0xf
    v_pk_mul_f32 v[176:177], v[176:177], v[80:81]
    v_pk_mul_f32 v[178:179], v[178:179], v[82:83]
    v_cvt_pk_bf16_f32 v192, v176, v177
    v_cvt_pk_bf16_f32 v193, v178, v179
    ds_write_b64 v72, v[192:193]
    v_fmac_f32_dpp v180, v148, v118 quad_perm:[1,0,3,2] row_mask:0xf bank_mask:0xf
    v_fmac_f32_dpp v181, v149, v118 quad_perm:[1,0,3,2] row_mask:0xf bank_mask:0xf
    v_fmac_f32_dpp v182, v150, v118 quad_perm:[1,0,3,2] row_mask:0xf bank_mask:0xf
    v_fmac_f32_dpp v183, v151, v118 quad_perm:[1,0,3,2] row_mask:0xf bank_mask:0xf
    v_fmac_f32_dpp v180, v164, v119 quad_perm:[1,0,3,2] row_mask:0xf bank_mask:0xf
    v_fmac_f32_dpp v181, v165, v119 quad_perm:[1,0,3,2] row_mask:0xf bank_mask:0xf
    v_fmac_f32_dpp v182, v166, v119 quad_perm:[1,0,3,2] row_mask:0xf bank_mask:0xf
    v_fmac_f32_dpp v183, v167, v119 quad_perm:[1,0,3,2] row_mask:0xf bank_mask:0xf
    v_pk_mul_f32 v[180:181], v[180:181], v[84:85]
    v_pk_mul_f32 v[182:183], v[182:183], v[86:87]
    v_cvt_pk_bf16_f32 v194, v180, v181
    v_cvt_pk_bf16_f32 v195, v182, v183
    ds_write_b64 v73, v[194:195]
    v_fmac_f32_dpp v184, v152, v118 quad_perm:[1,0,3,2] row_mask:0xf bank_mask:0xf
    v_fmac_f32_dpp v185, v153, v118 quad_perm:[1,0,3,2] row_mask:0xf bank_mask:0xf
    v_fmac_f32_dpp v186, v154, v118 quad_perm:[1,0,3,2] row_mask:0xf bank_mask:0xf
    v_fmac_f32_dpp v187, v155, v118 quad_perm:[1,0,3,2] row_mask:0xf bank_mask:0xf
    v_fmac_f32_dpp v184, v168, v119 quad_perm:[1,0,3,2] row_mask:0xf bank_mask:0xf
    v_fmac_f32_dpp v185, v169, v119 quad_perm:[1,0,3,2] row_mask:0xf bank_mask:0xf
    v_fmac_f32_dpp v186, v170, v119 quad_perm:[1,0,3,2] row_mask:0xf bank_mask:0xf
    v_fmac_f32_dpp v187, v171, v119 quad_perm:[1,0,3,2] row_mask:0xf bank_mask:0xf
    v_pk_mul_f32 v[184:185], v[184:185], v[88:89]
    v_pk_mul_f32 v[186:187], v[186:187], v[90:91]
    v_cvt_pk_bf16_f32 v196, v184, v185
    v_cvt_pk_bf16_f32 v197, v186, v187
    ds_write_b64 v74, v[196:197]
    v_fmac_f32_dpp v188, v156, v118 quad_perm:[1,0,3,2] row_mask:0xf bank_mask:0xf
    v_fmac_f32_dpp v189, v157, v118 quad_perm:[1,0,3,2] row_mask:0xf bank_mask:0xf
    v_fmac_f32_dpp v190, v158, v118 quad_perm:[1,0,3,2] row_mask:0xf bank_mask:0xf
    v_fmac_f32_dpp v191, v159, v118 quad_perm:[1,0,3,2] row_mask:0xf bank_mask:0xf
    v_fmac_f32_dpp v188, v172, v119 quad_perm:[1,0,3,2] row_mask:0xf bank_mask:0xf
    v_fmac_f32_dpp v189, v173, v119 quad_perm:[1,0,3,2] row_mask:0xf bank_mask:0xf
    v_fmac_f32_dpp v190, v174, v119 quad_perm:[1,0,3,2] row_mask:0xf bank_mask:0xf
    v_fmac_f32_dpp v191, v175, v119 quad_perm:[1,0,3,2] row_mask:0xf bank_mask:0xf
    v_pk_mul_f32 v[188:189], v[188:189], v[92:93]
    v_pk_mul_f32 v[190:191], v[190:191], v[94:95]
    v_cvt_pk_bf16_f32 v198, v188, v189
    v_cvt_pk_bf16_f32 v199, v190, v191
    ds_write_b64 v75, v[198:199]
    s_waitcnt vmcnt(10)
    ds_read_b64_tr_b16 v[104:105], v63 offset:0
    ds_read_b64_tr_b16 v[108:109], v63 offset:1024
    ds_read_b64_tr_b16 v[106:107], v63 offset:512
    ds_read_b64_tr_b16 v[110:111], v63 offset:1536
    ds_read_b64_tr_b16 v[96:97], v60
    ds_read_b64_tr_b16 v[98:99], v60 offset:1024
    ds_read_b64_tr_b16 v[100:101], v61
    ds_read_b64_tr_b16 v[102:103], v61 offset:1024
    s_mov_b32 s56, 0x05040100
    s_mov_b32 s57, 0x07060302
    s_waitcnt lgkmcnt(6)
    v_perm_b32 v120, v108, v104, s56
    v_perm_b32 v121, v108, v104, s57
    v_perm_b32 v122, v109, v105, s56
    v_perm_b32 v123, v109, v105, s57
    ds_write_b128 v68, v[120:123]
    s_waitcnt lgkmcnt(5)
    v_perm_b32 v124, v110, v106, s56
    v_perm_b32 v125, v110, v106, s57
    v_perm_b32 v126, v111, v107, s56
    v_perm_b32 v127, v111, v107, s57
    ds_write_b128 v69, v[124:127]
    s_waitcnt lgkmcnt(0)
    s_barrier
    ds_read_b128 v[144:147], v76 offset:0
    ds_read_b128 v[148:151], v76 offset:1024
    ds_read_b128 v[152:155], v67 offset:0
    ds_read_b128 v[156:159], v67 offset:1024
    ds_read_b64 v[12:13], v62
    v_xor_b32 v10, 16, v62
    ds_read_b64 v[14:15], v10
    v_xor_b32 v10, 32, v62
    ds_read_b64 v[16:17], v10
    v_xor_b32 v10, 48, v62
    ds_read_b64 v[18:19], v10
    s_waitcnt lgkmcnt(6)
    buffer_store_dwordx4 v[144:147], v77, s[12:15], s44 offen sc1
    buffer_store_dwordx4 v[148:151], v77, s[12:15], s45 offen sc1
    s_waitcnt lgkmcnt(4)
    buffer_store_dwordx4 v[152:155], v70, s[12:15], s46 offen sc1
    buffer_store_dwordx4 v[156:159], v71, s[12:15], s46 offen sc1
    s_waitcnt vmcnt(7)
    v_readfirstlane_b32 s60, v40
    s_cmp_ge_u32 s60, 12
    s_cbranch_scc1 L_pvd_2
    s_mov_b32 s61, 30000
L_pv_1:
    s_sleep 2
    buffer_load_dword v40, off, s[40:43], 0 sc1
    s_waitcnt vmcnt(0)
    v_readfirstlane_b32 s60, v40
    s_cmp_ge_u32 s60, 12
    s_cbranch_scc1 L_pvd_2
    s_sub_u32 s61, s61, 1
    s_cmp_lg_u32 s61, 0
    s_cbranch_scc1 L_pv_1
    s_or_b32 s47, s47, 1
L_pvd_2:
    s_waitcnt vmcnt(4)
    s_atomic_add s80, s[12:13], s66
    buffer_store_dwordx4 v[96:99], v66, s[12:15], 0 offen sc1
    buffer_store_dwordx4 v[100:103], v66, s[12:15], 0 offen offset:1024 sc1
    s_add_u32 m0, s64, 0x6000
    s_lshl_b32 s65, s75, 9
    buffer_load_dwordx4 v50, s[24:27], s65 offen lds
    s_mul_i32 s56, s52, 37
    s_lshr_b32 s56, s56, 8
    s_lshl_b32 s35, s56, 9
    s_lshl_b32 s59, s53, 11
    s_add_u32 s35, s35, s59
    s_lshl_b32 s59, s48, 7
    s_add_u32 s35, s35, s59
    s_add_u32 s35, s35, 0x130c000
    s_cmp_lt_u32 s52, 28
    s_cselect_b32 s35, s35, 0x7f000000
    s_add_u32 m0, s64, 0x6400
    s_lshl_b32 s65, s75, 9
    buffer_load_dwordx4 v51, s[24:27], s65 offen lds
    s_lshr_b32 s62, s53, 1
    s_lshl2_add_u32 s62, s62, s56
    s_mul_i32 s56, s56, 7
    s_sub_u32 s63, s52, s56
    s_and_b32 s56, s53, 1
    s_mul_i32 s56, s56, 7
    s_add_u32 s63, s63, s56
    s_lshl_b32 s56, s62, 1
    s_add_u32 s56, s56, s63
    s_add_u32 m0, s64, 0x8000
    s_lshl_b32 s65, s76, 9
    buffer_load_dwordx4 v50, s[24:27], s65 offen lds
    s_add_u32 s16, s56, 0
    s_and_b32 s16, s16, 7
    s_lshl_b32 s16, s16, 12
    s_add_u32 s17, s56, 1
    s_and_b32 s17, s17, 7
    s_lshl_b32 s17, s17, 12
    s_add_u32 s18, s56, 2
    s_and_b32 s18, s18, 7
    s_lshl_b32 s18, s18, 12
    s_add_u32 m0, s64, 0x8400
    s_lshl_b32 s65, s76, 9
    buffer_load_dwordx4 v51, s[24:27], s65 offen lds
    s_add_u32 s19, s56, 3
    s_and_b32 s19, s19, 7
    s_lshl_b32 s19, s19, 12
    s_add_u32 s20, s56, 4
    s_and_b32 s20, s20, 7
    s_lshl_b32 s20, s20, 12
    s_add_u32 s21, s56, 5
    s_and_b32 s21, s21, 7
    s_lshl_b32 s21, s21, 12
    s_add_u32 m0, s64, 0xa000
    s_lshl_b32 s65, s77, 9
    buffer_load_dwordx4 v50, s[24:27], s65 offen lds
    s_add_u32 s22, s56, 6
    s_and_b32 s22, s22, 7
    s_lshl_b32 s22, s22, 12
    s_add_u32 s23, s56, 7
    s_and_b32 s23, s23, 7
    s_lshl_b32 s23, s23, 12
    s_lshr_b32 s56, s52, 3
    s_lshl_b32 s56, s56, 1
    s_add_u32 s56, s56, s50
    s_add_u32 m0, s64, 0xa400
    s_lshl_b32 s65, s77, 9
    buffer_load_dwordx4 v51, s[24:27], s65 offen lds
    s_mul_i32 s57, s56, 37
    s_lshr_b32 s57, s57, 8
    s_mul_i32 s57, s57, 7
    s_sub_u32 s56, s56, s57
    s_add_u32 s4, s56, 0
    s_cmp_ge_u32 s4, 7
    s_cselect_b32 s59, 7, 0
    s_sub_u32 s4, s4, s59
    s_lshl_b32 s4, s4, 12
    s_add_u32 m0, s64, 0xc000
    s_lshl_b32 s65, s78, 9
    buffer_load_dwordx4 v50, s[24:27], s65 offen lds
    s_add_u32 s5, s56, 1
    s_cmp_ge_u32 s5, 7
    s_cselect_b32 s59, 7, 0
    s_sub_u32 s5, s5, s59
    s_lshl_b32 s5, s5, 12
    s_add_u32 s6, s56, 2
    s_cmp_ge_u32 s6, 7
    s_cselect_b32 s59, 7, 0
    s_sub_u32 s6, s6, s59
    s_add_u32 m0, s64, 0xc400
    s_lshl_b32 s65, s78, 9
    buffer_load_dwordx4 v51, s[24:27], s65 offen lds
    s_lshl_b32 s6, s6, 12
    s_add_u32 s7, s56, 3
    s_cmp_ge_u32 s7, 7
    s_cselect_b32 s59, 7, 0
    s_sub_u32 s7, s7, s59
    s_lshl_b32 s7, s7, 12
    s_add_u32 s8, s56, 4
    s_cmp_ge_u32 s8, 7
    s_cselect_b32 s59, 7, 0
    s_add_u32 m0, s64, 0xe000
    s_lshl_b32 s65, s79, 9
    buffer_load_dwordx4 v50, s[24:27], s65 offen lds
    s_sub_u32 s8, s8, s59
    s_lshl_b32 s8, s8, 12
    s_add_u32 s9, s56, 5
    s_cmp_ge_u32 s9, 7
    s_cselect_b32 s59, 7, 0
    s_sub_u32 s9, s9, s59
    s_lshl_b32 s9, s9, 12
    s_add_u32 s10, s56, 6
    s_cmp_ge_u32 s10, 7
    s_cselect_b32 s59, 7, 0
    s_add_u32 m0, s64, 0xe400
    s_lshl_b32 s65, s79, 9
    buffer_load_dwordx4 v51, s[24:27], s65 offen lds
    s_sub_u32 s10, s10, s59
    s_lshl_b32 s10, s10, 12
    s_lshl_b32 s68, s52, 9
    s_add_u32 s68, s68, 0x1308000
    s_sub_u32 s56, s2, 1
    s_bfe_u32 s56, s56, 0x40004
    s_lshl_b32 s69, s56, 10
    s_add_u32 s69, s69, 0x1310000
    s_lshl_b32 s70, s50, 11
    s_lshl_b32 s59, s48, 9
    s_add_u32 s70, s70, s59
    s_add_u32 s70, s70, 0x130c000
    s_mul_i32 s57, s50, 229376
    s_mul_i32 s56, s48, 57344
    s_lshl_b32 s58, s54, 10
    s_add_u32 s58, s58, s56
    s_add_u32 s58, s58, s57
    s_add_u32 s58, s58, 0x1400000
    v_add_u32 v28, s58, v30
    v_xor_b32 v29, 0x400, v28
    s_lshl_b32 s67, s55, 15
    s_lshl_b32 s59, s54, 11
    s_add_u32 s67, s67, s59
    s_lshl_b32 s56, s49, 16
    s_add_u32 s56, s56, s67
    v_add_u32 v46, s56, v30
    s_lshl_b32 s56, s55, 15
    s_add_u32 s56, s56, 0x10000
    v_add_u32 v47, s56, v30
    s_lshl_b32 s56, s49, 10
    s_lshl_b32 s59, s48, 8
    s_add_u32 s56, s56, s59
    s_add_u32 s56, s56, 0x1280000
    v_lshl_add_u32 v48, v35, 3, s56
    s_and_b32 s34, s52, 3
    s_lshl_b32 s34, s34, 12
    s_lshl_b32 s59, s48, 10
    s_add_u32 s34, s34, s59
    s_lshl_b32 s59, s53, 7
    s_add_u32 s34, s34, s59
    s_add_u32 s34, s34, 0x1310000
    s_and_b32 s32, s49, 3
    s_lshl_b32 s32, s32, 7
    s_lshl_b32 s59, s50, 11
    s_add_u32 s32, s32, s59
    s_lshl_b32 s59, s48, 9
    s_add_u32 s32, s32, s59
    s_add_u32 s32, s32, 0x1308000
    s_waitcnt lgkmcnt(0)
    s_load_dword s60, s[12:13], s66 glc
    v_and_b32 v128, 15, v34
    v_cvt_f32_u32 v122, v128
    s_lshl_b32 s44, s48, 4
    v_add_u32 v128, s44, v128
    v_cvt_f32_u32 v121, v128
    v_lshrrev_b32 v128, 4, v34
    v_lshlrev_b32 v128, 2, v128
    v_cvt_f32_u32 v120, v128
    s_lshr_b32 s44, s2, 7
    s_add_u32 s44, s44, 1
    s_sub_u32 s45, 0, s44
    s_bitcmp1_b32 s2, 6
    s_cselect_b32 s44, s45, s44
    v_cvt_f32_i32 v127, s44
    v_sub_f32 v127, v120, v127
    v_and_b32 v128, 1, v34
    v_cmp_eq_u32 s[26:27], 1, v128
    v_mul_u32_u24 v126, 0x8000, v128
    v_lshl_or_b32 v126, v126, 16, v126
    v_and_b32 v129, 2, v34
    v_lshlrev_b32 v129, 14, v129
    v_lshl_or_b32 v134, v129, 16, v129
    v_xor_b32 v124, v134, v126
    v_mul_f32 v125, 0x3c800000, v121
    v_mul_f32 v123, v125, v120
    v_fmamk_f32 v128, v125, 0x00000000, v123
    v_add_f32 v129, v128, v125
    v_cos_f32 v130, v128
    v_cos_f32 v131, v129
    v_sin_f32 v132, v128
    v_sin_f32 v133, v129
    v_cvt_pk_bf16_f32 v136, v130, v131
    v_cvt_pk_bf16_f32 v144, v132, v133
    v_fmamk_f32 v128, v125, 0x40000000, v123
    v_add_f32 v129, v128, v125
    v_cos_f32 v130, v128
    v_cos_f32 v131, v129
    v_sin_f32 v132, v128
    v_sin_f32 v133, v129
    v_cvt_pk_bf16_f32 v137, v130, v131
    v_cvt_pk_bf16_f32 v145, v132, v133
    v_cndmask_b32 v138, v136, v144, s[26:27]
    v_cndmask_b32 v146, v144, v136, s[26:27]
    v_xor_b32 v138, v124, v138
    v_xor_b32 v146, v134, v146
    v_cndmask_b32 v139, v137, v145, s[26:27]
    v_cndmask_b32 v147, v145, v137, s[26:27]
    v_xor_b32 v139, v124, v139
    v_xor_b32 v147, v134, v147
    v_xor_b32 v140, v126, v136
    v_xor_b32 v148, v126, v144
    v_xor_b32 v141, v126, v137
    v_xor_b32 v149, v126, v145
    v_xor_b32 v142, v126, v138
    v_xor_b32 v150, v126, v146
    v_xor_b32 v143, v126, v139
    v_xor_b32 v151, v126, v147
    v_xor_b32 v152, 0x80008000, v144
    v_xor_b32 v153, 0x80008000, v145
    v_xor_b32 v154, 0x80008000, v146
    v_xor_b32 v155, 0x80008000, v147
    v_xor_b32 v156, 0x80008000, v148
    v_xor_b32 v157, 0x80008000, v149
    v_xor_b32 v158, 0x80008000, v150
    v_xor_b32 v159, 0x80008000, v151
    v_mul_f32 v125, 0x3d000000, v122
    s_mov_b32 s45, 0x80000000
    s_bitcmp1_b32 s44, 0
    s_cselect_b32 s45, 0x8000, s45
    v_mul_f32 v123, v125, v127
    v_fmamk_f32 v128, v125, 0x00000000, v123
    v_add_f32 v129, v128, v125
    v_cos_f32 v130, v128
    v_cos_f32 v131, v129
    v_sin_f32 v132, v128
    v_sin_f32 v133, v129
    v_cvt_pk_bf16_f32 v160, v130, v131
    v_cvt_pk_bf16_f32 v168, v132, v133
    v_fmamk_f32 v128, v125, 0x40000000, v123
    v_add_f32 v129, v128, v125
    v_cos_f32 v130, v128
    v_cos_f32 v131, v129
    v_sin_f32 v132, v128
    v_sin_f32 v133, v129
    v_cvt_pk_bf16_f32 v161, v130, v131
    v_cvt_pk_bf16_f32 v169, v132, v133
    v_xor_b32 v162, v126, v160
    v_xor_b32 v170, v126, v168
    v_xor_b32 v163, v126, v161
    v_xor_b32 v171, v126, v169
    v_xor_b32 v164, s45, v160
    v_xor_b32 v172, s45, v168
    v_xor_b32 v165, s45, v161
    v_xor_b32 v173, s45, v169
    v_xor_b32 v166, s45, v162
    v_xor_b32 v174, s45, v170
    v_xor_b32 v167, s45, v163
    v_xor_b32 v175, s45, v171
    v_xor_b32 v176, 0x80008000, v168
    v_xor_b32 v177, 0x80008000, v169
    v_xor_b32 v178, 0x80008000, v170
    v_xor_b32 v179, 0x80008000, v171
    v_xor_b32 v180, 0x80008000, v172
    v_xor_b32 v181, 0x80008000, v173
    v_xor_b32 v182, 0x80008000, v174
    v_xor_b32 v183, 0x80008000, v175
    v_mul_f32 v123, v125, v120
    v_fmamk_f32 v128, v125, 0x00000000, v123
    v_add_f32 v129, v128, v125
    v_cos_f32 v130, v128
    v_cos_f32 v131, v129
    v_sin_f32 v132, v128
    v_sin_f32 v133, v129
    v_cvt_pk_bf16_f32 v184, v130, v131
    v_cvt_pk_bf16_f32 v192, v132, v133
    v_fmamk_f32 v128, v125, 0x40000000, v123
    v_add_f32 v129, v128, v125
    v_cos_f32 v130, v128
    v_cos_f32 v131, v129
    v_sin_f32 v132, v128
    v_sin_f32 v133, v129
    v_cvt_pk_bf16_f32 v185, v130, v131
    s_barrier
    s_waitcnt vmcnt(12)
    s_atomic_add s80, s[12:13], s32
    s_atomic_add s80, s[12:13], s34
    s_waitcnt lgkmcnt(0)
    s_cmp_ge_u32 s60, 8
    s_cbranch_scc1 L_psd_7
    s_mov_b32 s61, 30000
L_ps_6:
    s_load_dword s60, s[12:13], s66 glc
    s_waitcnt lgkmcnt(0)
    s_cmp_ge_u32 s60, 8
    s_cbranch_scc1 L_psd_7
    s_sub_u32 s61, s61, 1
    s_cmp_lg_u32 s61, 0
    s_cbranch_scc1 L_ps_6
    s_or_b32 s47, s47, 2
L_psd_7:
    s_mov_b32 s33, s70
    s_add_u32 m0, s67, 0x10000
    s_lshl_b32 s65, s72, 5
    buffer_load_dwordx4 v46, s[12:15], s65 offen sc1 lds
    v_cvt_pk_bf16_f32 v193, v132, v133
    v_xor_b32 v186, v126, v184
    v_xor_b32 v194, v126, v192
    v_xor_b32 v187, v126, v185
    v_xor_b32 v195, v126, v193
    v_xor_b32 v188, 0x80000000, v184
    v_xor_b32 v196, 0x80000000, v192
    s_add_u32 m0, s67, 0x10000
    s_lshl_b32 s65, s72, 5
    buffer_load_dwordx4 v46, s[12:15], s65 offen offset:1024 sc1 lds
    v_xor_b32 v189, 0x80000000, v185
    v_xor_b32 v197, 0x80000000, v193
    v_xor_b32 v190, 0x80000000, v186
    v_xor_b32 v198, 0x80000000, v194
    v_xor_b32 v191, 0x80000000, v187
    v_xor_b32 v199, 0x80000000, v195
    v_xor_b32 v200, 0x80008000, v192
    s_add_u32 m0, s67, 0x11000
    s_lshl_b32 s65, s73, 5
    buffer_load_dwordx4 v46, s[12:15], s65 offen sc1 lds
    v_xor_b32 v201, 0x80008000, v193
    v_xor_b32 v202, 0x80008000, v194
    v_xor_b32 v203, 0x80008000, v195
    v_xor_b32 v204, 0x80008000, v196
    v_xor_b32 v205, 0x80008000, v197
    v_xor_b32 v206, 0x80008000, v198
    v_xor_b32 v207, 0x80008000, v199
    s_add_u32 m0, s67, 0x11000
    s_lshl_b32 s65, s73, 5
    buffer_load_dwordx4 v46, s[12:15], s65 offen offset:1024 sc1 lds
    v_mul_f32 v125, 0x3a000000, v121
    v_mul_f32 v123, v125, v127
    v_fmamk_f32 v128, v125, 0x00000000, v123
    v_cos_f32 v80, v128
    v_sin_f32 v88, v128
    buffer_load_dwordx2 v[50:51], v48, s[12:15], 0 offen sc1
    v_fmamk_f32 v129, v125, 0x3f800000, v123
    v_cos_f32 v81, v129
    v_sin_f32 v89, v129
    v_fmamk_f32 v128, v125, 0x40000000, v123
    v_cos_f32 v82, v128
    v_sin_f32 v90, v128
    s_add_u32 m0, s67, 0x12000
    s_lshl_b32 s65, s74, 5
    buffer_load_dwordx4 v46, s[12:15], s65 offen sc1 lds
    v_fmamk_f32 v129, v125, 0x40400000, v123
    v_cos_f32 v83, v129
    v_sin_f32 v91, v129
    v_fmamk_f32 v128, v125, 0x41800000, v123
    v_cos_f32 v84, v128
    s_add_u32 m0, s67, 0x12000
    s_lshl_b32 s65, s74, 5
    buffer_load_dwordx4 v46, s[12:15], s65 offen offset:1024 sc1 lds
    v_sin_f32 v92, v128
    v_fmamk_f32 v129, v125, 0x41880000, v123
    v_cos_f32 v85, v129
    v_sin_f32 v93, v129
    s_add_u32 m0, s67, 0x13000
    s_lshl_b32 s65, s75, 5
    buffer_load_dwordx4 v46, s[12:15], s65 offen sc1 lds
    v_fmamk_f32 v128, v125, 0x41900000, v123
    v_cos_f32 v86, v128
    v_sin_f32 v94, v128
    v_fmamk_f32 v129, v125, 0x41980000, v123
    v_cos_f32 v87, v129
    s_add_u32 m0, s67, 0x13000
    s_lshl_b32 s65, s75, 5
    buffer_load_dwordx4 v46, s[12:15], s65 offen offset:1024 sc1 lds
    v_sin_f32 v95, v129
    v_mul_f32 v125, 0x3a000000, v122
    v_add_f32 v126, 0x3c000000, v125
    v_sub_f32 v121, v121, v122
    v_add_f32 v121, v121, v120
    v_mul_f32 v123, v125, v121
    s_add_u32 m0, s67, 0x14000
    s_lshl_b32 s65, s76, 5
    buffer_load_dwordx4 v46, s[12:15], s65 offen sc1 lds
    v_mul_f32 v124, v126, v121
    s_mov_b32 s44, 0x36000000
    s_cmp_eq_u32 s2, 0
    s_cselect_b32 s44, 0x35800000, s44
    v_fmamk_f32 v128, v125, 0x00000000, v123
    v_cos_f32 v130, v128
    s_add_u32 m0, s67, 0x14000
    s_lshl_b32 s65, s76, 5
    buffer_load_dwordx4 v46, s[12:15], s65 offen offset:1024 sc1 lds
    v_sin_f32 v131, v128
    v_mul_f32 v104, s44, v130
    v_mul_f32 v112, s44, v131
    v_fmamk_f32 v128, v125, 0x3f800000, v123
    v_cos_f32 v130, v128
    s_add_u32 m0, s67, 0x15000
    s_lshl_b32 s65, s77, 5
    buffer_load_dwordx4 v46, s[12:15], s65 offen sc1 lds
    v_sin_f32 v131, v128
    v_mul_f32 v105, s44, v130
    v_mul_f32 v113, s44, v131
    v_fmamk_f32 v128, v125, 0x40000000, v123
    v_cos_f32 v130, v128
    s_add_u32 m0, s67, 0x15000
    s_lshl_b32 s65, s77, 5
    buffer_load_dwordx4 v46, s[12:15], s65 offen offset:1024 sc1 lds
    v_sin_f32 v131, v128
    v_mul_f32 v106, s44, v130
    v_mul_f32 v114, s44, v131
    v_fmamk_f32 v128, v125, 0x40400000, v123
    v_cos_f32 v130, v128
    s_add_u32 m0, s67, 0x16000
    s_lshl_b32 s65, s78, 5
    buffer_load_dwordx4 v46, s[12:15], s65 offen sc1 lds
    v_sin_f32 v131, v128
    v_mul_f32 v107, s44, v130
    v_mul_f32 v115, s44, v131
    v_fmamk_f32 v128, v126, 0x00000000, v124
    v_cos_f32 v130, v128
    s_add_u32 m0, s67, 0x16000
    s_lshl_b32 s65, s78, 5
    buffer_load_dwordx4 v46, s[12:15], s65 offen offset:1024 sc1 lds
    v_sin_f32 v131, v128
    v_mul_f32 v108, s44, v130
    v_mul_f32 v116, s44, v131
    v_fmamk_f32 v128, v126, 0x3f800000, v124
    v_cos_f32 v130, v128
    s_add_u32 m0, s67, 0x17000
    s_lshl_b32 s65, s79, 5
    buffer_load_dwordx4 v46, s[12:15], s65 offen sc1 lds
    v_sin_f32 v131, v128
    v_mul_f32 v109, s44, v130
    v_mul_f32 v117, s44, v131
    v_fmamk_f32 v128, v126, 0x40000000, v124
    v_cos_f32 v130, v128
    s_add_u32 m0, s67, 0x17000
    s_lshl_b32 s65, s79, 5
    buffer_load_dwordx4 v46, s[12:15], s65 offen offset:1024 sc1 lds
    v_sin_f32 v131, v128
    v_mul_f32 v110, s44, v130
    v_mul_f32 v118, s44, v131
    v_fmamk_f32 v128, v126, 0x40400000, v124
    v_cos_f32 v130, v128
    s_lshl2_add_u32 s65, s2, s48
    s_mul_i32 s65, s65, 1792
    s_mov_b64 exec, 0x3fff
    buffer_load_dword v45, v79, s[28:31], s65 offen
    s_mov_b64 exec, -1
    v_sin_f32 v131, v128
    v_mul_f32 v111, s44, v130
    v_mul_f32 v119, s44, v131
    s_waitcnt vmcnt(14)
    s_barrier
    ds_read_b64_tr_b16 a[0:1], v59 offset:0
    ds_read_b64_tr_b16 a[2:3], v59 offset:1024
    ds_read_b128 a[64:67], v47 offset:0
    ds_read_b64_tr_b16 a[4:5], v59 offset:2048
    ds_read_b64_tr_b16 a[6:7], v59 offset:3072
    ds_read_b128 a[68:71], v47 offset:1024
    ds_read_b64_tr_b16 a[8:9], v59 offset:4096
    ds_read_b64_tr_b16 a[10:11], v59 offset:5120
    ds_read_b128 a[72:75], v47 offset:2048
    ds_read_b64_tr_b16 a[12:13], v59 offset:6144
    ds_read_b64_tr_b16 a[14:15], v59 offset:7168
    ds_read_b128 a[76:79], v47 offset:3072
    ds_read_b64_tr_b16 a[16:17], v59 offset:8192
    ds_read_b64_tr_b16 a[18:19], v59 offset:9216
    ds_read_b128 a[80:83], v47 offset:4096
    ds_read_b64_tr_b16 a[20:21], v59 offset:10240
    ds_read_b64_tr_b16 a[22:23], v59 offset:11264
    ds_read_b128 a[84:87], v47 offset:5120
    ds_read_b64_tr_b16 a[24:25], v59 offset:12288
    ds_read_b64_tr_b16 a[26:27], v59 offset:13312
    ds_read_b128 a[88:91], v47 offset:6144
    ds_read_b64_tr_b16 a[28:29], v59 offset:14336
    ds_read_b64_tr_b16 a[30:31], v59 offset:15360
    ds_read_b128 a[92:95], v47 offset:7168
    s_cmp_eq_u32 s35, 0x7f000000
    s_cbranch_scc1 L_ns_8
    s_atomic_add s80, s[12:13], s35
L_ns_8:
    s_waitcnt vmcnt(9)
    s_barrier
    s_waitcnt lgkmcnt(14)
    v_mfma_f32_32x32x16_bf16 v[208:223], a[0:3], a[64:67], 0
    ds_read_b64_tr_b16 a[32:33], v59 offset:16384
    ds_read_b64_tr_b16 a[34:35], v59 offset:17408
    ds_read_b128 a[96:99], v47 offset:8192
    v_mfma_f32_32x32x16_bf16 v[208:223], a[4:7], a[68:71], v[208:223]
    ds_read_b64_tr_b16 a[36:37], v59 offset:18432
    ds_read_b64_tr_b16 a[38:39], v59 offset:19456
    ds_read_b128 a[100:103], v47 offset:9216
    ds_read_b64_tr_b16 a[40:41], v59 offset:20480
    v_mfma_f32_32x32x16_bf16 v[208:223], a[8:11], a[72:75], v[208:223]
    s_waitcnt lgkmcnt(14)
    ds_read_b64_tr_b16 a[42:43], v59 offset:21504
    ds_read_b128 a[104:107], v47 offset:10240
    ds_read_b64_tr_b16 a[44:45], v59 offset:22528
    v_mfma_f32_32x32x16_bf16 v[208:223], a[12:15], a[76:79], v[208:223]
    ds_read_b64_tr_b16 a[46:47], v59 offset:23552
    ds_read_b128 a[108:111], v47 offset:11264
    ds_read_b64_tr_b16 a[48:49], v59 offset:24576
    ds_read_b64_tr_b16 a[50:51], v59 offset:25600
    v_mfma_f32_32x32x16_bf16 v[208:223], a[16:19], a[80:83], v[208:223]
    s_waitcnt lgkmcnt(14)
    ds_read_b128 a[112:115], v47 offset:12288
    ds_read_b64_tr_b16 a[52:53], v59 offset:26624
    ds_read_b64_tr_b16 a[54:55], v59 offset:27648
    v_mfma_f32_32x32x16_bf16 v[208:223], a[20:23], a[84:87], v[208:223]
    ds_read_b128 a[116:119], v47 offset:13312
    ds_read_b64_tr_b16 a[56:57], v59 offset:28672
    ds_read_b64_tr_b16 a[58:59], v59 offset:29696
    ds_read_b128 a[120:123], v47 offset:14336
    v_mfma_f32_32x32x16_bf16 v[208:223], a[24:27], a[88:91], v[208:223]
    ds_read_b64_tr_b16 a[60:61], v59 offset:30720
    ds_read_b64_tr_b16 a[62:63], v59 offset:31744
    ds_read_b128 a[124:127], v47 offset:15360
    v_mfma_f32_32x32x16_bf16 v[208:223], a[28:31], a[92:95], v[208:223]
    s_waitcnt vmcnt(5)
    s_barrier
    s_waitcnt lgkmcnt(14)
    v_mfma_f32_32x32x16_bf16 v[208:223], a[32:35], a[96:99], v[208:223]
    ds_read_b64_tr_b16 a[0:1], v59 offset:32768
    ds_read_b64_tr_b16 a[2:3], v59 offset:33792
    ds_read_b128 a[64:67], v47 offset:16384
    v_mfma_f32_32x32x16_bf16 v[208:223], a[36:39], a[100:103], v[208:223]
    ds_read_b64_tr_b16 a[4:5], v59 offset:34816
    ds_read_b64_tr_b16 a[6:7], v59 offset:35840
    ds_read_b128 a[68:71], v47 offset:17408
    ds_read_b64_tr_b16 a[8:9], v59 offset:36864
    v_mfma_f32_32x32x16_bf16 v[208:223], a[40:43], a[104:107], v[208:223]
    s_waitcnt lgkmcnt(14)
    ds_read_b64_tr_b16 a[10:11], v59 offset:37888
    ds_read_b128 a[72:75], v47 offset:18432
    ds_read_b64_tr_b16 a[12:13], v59 offset:38912
    v_mfma_f32_32x32x16_bf16 v[208:223], a[44:47], a[108:111], v[208:223]
    ds_read_b64_tr_b16 a[14:15], v59 offset:39936
    ds_read_b128 a[76:79], v47 offset:19456
    ds_read_b64_tr_b16 a[16:17], v59 offset:40960
    ds_read_b64_tr_b16 a[18:19], v59 offset:41984
    v_mfma_f32_32x32x16_bf16 v[208:223], a[48:51], a[112:115], v[208:223]
    s_waitcnt lgkmcnt(14)
    ds_read_b128 a[80:83], v47 offset:20480
    ds_read_b64_tr_b16 a[20:21], v59 offset:43008
    ds_read_b64_tr_b16 a[22:23], v59 offset:44032
    v_mfma_f32_32x32x16_bf16 v[208:223], a[52:55], a[116:119], v[208:223]
    ds_read_b128 a[84:87], v47 offset:21504
    ds_read_b64_tr_b16 a[24:25], v59 offset:45056
    ds_read_b64_tr_b16 a[26:27], v59 offset:46080
    ds_read_b128 a[88:91], v47 offset:22528
    v_mfma_f32_32x32x16_bf16 v[208:223], a[56:59], a[120:123], v[208:223]
    ds_read_b64_tr_b16 a[28:29], v59 offset:47104
    ds_read_b64_tr_b16 a[30:31], v59 offset:48128
    ds_read_b128 a[92:95], v47 offset:23552
    v_mfma_f32_32x32x16_bf16 v[208:223], a[60:63], a[124:127], v[208:223]
    s_waitcnt vmcnt(1)
    s_barrier
    buffer_load_dword v40, v43, s[12:15], s68 offen sc1
    buffer_load_dword v41, v44, s[12:15], s69 offen sc1
    s_waitcnt lgkmcnt(14)
    v_mfma_f32_32x32x16_bf16 v[208:223], a[0:3], a[64:67], v[208:223]
    ds_read_b64_tr_b16 a[32:33], v59 offset:49152
    ds_read_b64_tr_b16 a[34:35], v59 offset:50176
    ds_read_b128 a[96:99], v47 offset:24576
    v_mfma_f32_32x32x16_bf16 v[208:223], a[4:7], a[68:71], v[208:223]
    ds_read_b64_tr_b16 a[36:37], v59 offset:51200
    ds_read_b64_tr_b16 a[38:39], v59 offset:52224
    ds_read_b128 a[100:103], v47 offset:25600
    ds_read_b64_tr_b16 a[40:41], v59 offset:53248
    v_mfma_f32_32x32x16_bf16 v[208:223], a[8:11], a[72:75], v[208:223]
    s_waitcnt lgkmcnt(14)
    ds_read_b64_tr_b16 a[42:43], v59 offset:54272
    ds_read_b128 a[104:107], v47 offset:26624
    ds_read_b64_tr_b16 a[44:45], v59 offset:55296
    v_mfma_f32_32x32x16_bf16 v[208:223], a[12:15], a[76:79], v[208:223]
    ds_read_b64_tr_b16 a[46:47], v59 offset:56320
    ds_read_b128 a[108:111], v47 offset:27648
    ds_read_b64_tr_b16 a[48:49], v59 offset:57344
    ds_read_b64_tr_b16 a[50:51], v59 offset:58368
    v_mfma_f32_32x32x16_bf16 v[208:223], a[16:19], a[80:83], v[208:223]
    s_waitcnt lgkmcnt(14)
    ds_read_b128 a[112:115], v47 offset:28672
    ds_read_b64_tr_b16 a[52:53], v59 offset:59392
    ds_read_b64_tr_b16 a[54:55], v59 offset:60416
    v_mfma_f32_32x32x16_bf16 v[208:223], a[20:23], a[84:87], v[208:223]
    ds_read_b128 a[116:119], v47 offset:29696
    ds_read_b64_tr_b16 a[56:57], v59 offset:61440
    ds_read_b64_tr_b16 a[58:59], v59 offset:62464
    ds_read_b128 a[120:123], v47 offset:30720
    v_mfma_f32_32x32x16_bf16 v[208:223], a[24:27], a[88:91], v[208:223]
    ds_read_b64_tr_b16 a[60:61], v59 offset:63488
    ds_read_b64_tr_b16 a[62:63], v59 offset:64512
    ds_read_b128 a[124:127], v47 offset:31744
    v_mfma_f32_32x32x16_bf16 v[208:223], a[28:31], a[92:95], v[208:223]
    s_waitcnt lgkmcnt(14)
    v_mfma_f32_32x32x16_bf16 v[208:223], a[32:35], a[96:99], v[208:223]
    v_lshlrev_b32 v224, 16, v12
    v_and_b32 v225, 0xffff0000, v12
    v_lshlrev_b32 v226, 16, v13
    v_and_b32 v227, 0xffff0000, v13
    v_lshlrev_b32 v228, 16, v14
    v_mfma_f32_32x32x16_bf16 v[208:223], a[36:39], a[100:103], v[208:223]
    v_and_b32 v229, 0xffff0000, v14
    v_lshlrev_b32 v230, 16, v15
    v_and_b32 v231, 0xffff0000, v15
    v_lshlrev_b32 v232, 16, v16
    v_and_b32 v233, 0xffff0000, v16
    v_mfma_f32_32x32x16_bf16 v[208:223], a[40:43], a[104:107], v[208:223]
    s_waitcnt lgkmcnt(12)
    v_lshlrev_b32 v234, 16, v17
    v_and_b32 v235, 0xffff0000, v17
    v_lshlrev_b32 v236, 16, v18
    v_and_b32 v237, 0xffff0000, v18
    v_lshlrev_b32 v238, 16, v19
    v_mfma_f32_32x32x16_bf16 v[208:223], a[44:47], a[108:111], v[208:223]
    s_waitcnt lgkmcnt(9)
    v_and_b32 v239, 0xffff0000, v19
    v_sub_f32 v224, v224, v50
    v_sub_f32 v225, v225, v50
    v_sub_f32 v226, v226, v50
    v_mfma_f32_32x32x16_bf16 v[208:223], a[48:51], a[112:115], v[208:223]
    s_waitcnt lgkmcnt(6)
    v_sub_f32 v227, v227, v50
    v_sub_f32 v228, v228, v50
    v_sub_f32 v229, v229, v50
    v_sub_f32 v230, v230, v50
    v_sub_f32 v231, v231, v50
    v_mfma_f32_32x32x16_bf16 v[208:223], a[52:55], a[116:119], v[208:223]
    s_waitcnt lgkmcnt(3)
    v_sub_f32 v232, v232, v50
    v_sub_f32 v233, v233, v50
    v_sub_f32 v234, v234, v50
    v_sub_f32 v235, v235, v50
    v_sub_f32 v236, v236, v50
    v_mfma_f32_32x32x16_bf16 v[208:223], a[56:59], a[120:123], v[208:223]
    s_waitcnt lgkmcnt(0)
    v_sub_f32 v237, v237, v50
    v_sub_f32 v238, v238, v50
    v_sub_f32 v239, v239, v50
    s_lshl_b32 s58, s49, 16
    s_lshl_b32 s59, s55, 15
    v_mfma_f32_32x32x16_bf16 v[208:223], a[60:63], a[124:127], v[208:223]
    s_add_u32 s58, s58, s59
    s_lshl_b32 s59, s50, 12
    s_add_u32 s58, s58, s59
    s_lshl_b32 s59, s54, 11
    s_add_u32 s58, s58, s59
    s_add_u32 s58, s58, 0x200000
    s_lshl_b32 s56, s49, 13
    s_lshl_b32 s59, s55, 12
    s_add_u32 s56, s56, s59
    s_lshl_b32 s59, s54, 11
    s_add_u32 s56, s56, s59
    s_lshl_b32 s59, s50, 8
    s_add_u32 s56, s56, s59
    s_add_u32 s56, s56, 0x1290000
    v_lshlrev_b32 v4, 3, v35
    v_lshl_or_b32 v4, v36, 2, v4
    s_barrier
    v_pk_fma_f32 v[208:209], v[224:225], v[50:51], v[208:209] op_sel:[0,1,0] op_sel_hi:[1,1,1]
    v_pk_fma_f32 v[210:211], v[226:227], v[50:51], v[210:211] op_sel:[0,1,0] op_sel_hi:[1,1,1]
    v_pk_fma_f32 v[212:213], v[228:229], v[50:51], v[212:213] op_sel:[0,1,0] op_sel_hi:[1,1,1]
    v_pk_fma_f32 v[214:215], v[230:231], v[50:51], v[214:215] op_sel:[0,1,0] op_sel_hi:[1,1,1]
    v_pk_fma_f32 v[216:217], v[232:233], v[50:51], v[216:217] op_sel:[0,1,0] op_sel_hi:[1,1,1]
    v_pk_fma_f32 v[218:219], v[234:235], v[50:51], v[218:219] op_sel:[0,1,0] op_sel_hi:[1,1,1]
    v_pk_fma_f32 v[220:221], v[236:237], v[50:51], v[220:221] op_sel:[0,1,0] op_sel_hi:[1,1,1]
    v_pk_fma_f32 v[222:223], v[238:239], v[50:51], v[222:223] op_sel:[0,1,0] op_sel_hi:[1,1,1]
    v_cvt_pk_bf16_f32 v20, v208, v209
    v_cvt_pk_bf16_f32 v21, v210, v211
    v_cvt_pk_bf16_f32 v22, v212, v213
    v_cvt_pk_bf16_f32 v23, v214, v215
    v_cvt_pk_bf16_f32 v24, v216, v217
    v_cvt_pk_bf16_f32 v25, v218, v219
    v_cvt_pk_bf16_f32 v26, v220, v221
    v_cvt_pk_bf16_f32 v27, v222, v223
    buffer_store_dwordx4 v[20:23], v30, s[12:15], s58 offen sc1
    buffer_store_dwordx4 v[24:27], v30, s[12:15], s58 offen offset:1024 sc1
    v_pk_add_f32 v[224:225], v[208:209], v[216:217]
    v_pk_add_f32 v[226:227], v[210:211], v[218:219]
    v_pk_add_f32 v[228:229], v[212:213], v[220:221]
    v_pk_add_f32 v[230:231], v[214:215], v[222:223]
    v_pk_mul_f32 v[232:233], v[208:209], v[208:209]
    v_pk_mul_f32 v[234:235], v[210:211], v[210:211]
    v_pk_mul_f32 v[236:237], v[212:213], v[212:213]
    v_pk_mul_f32 v[238:239], v[214:215], v[214:215]
    v_pk_fma_f32 v[232:233], v[216:217], v[216:217], v[232:233]
    v_pk_fma_f32 v[234:235], v[218:219], v[218:219], v[234:235]
    v_pk_fma_f32 v[236:237], v[220:221], v[220:221], v[236:237]
    v_pk_fma_f32 v[238:239], v[222:223], v[222:223], v[238:239]
    v_pk_add_f32 v[224:225], v[224:225], v[226:227]
    v_pk_add_f32 v[228:229], v[228:229], v[230:231]
    v_pk_add_f32 v[232:233], v[232:233], v[234:235]
    v_pk_add_f32 v[236:237], v[236:237], v[238:239]
    v_pk_add_f32 v[224:225], v[224:225], v[228:229]
    v_pk_add_f32 v[232:233], v[232:233], v[236:237]
    v_add_f32 v224, v224, v225
    v_add_f32 v232, v232, v233
    s_lshl_b32 s57, s54, 5
    v_add_u32 v5, s57, v37
    v_permlane32_swap_b32 v224, v232
    v_add_f32 v224, v224, v232
    buffer_store_dword v224, v4, s[12:15], s56 offen sc1
    v_mul_u32_u24 v5, 3584, v5
    s_lshl_b32 s56, s63, 8
    s_lshl_b32 s59, s55, 7
    s_add_u32 s56, s56, s59
    v_add3_u32 v60, v5, s56, v39
    v_add_u32 v61, 28672, v60
    v_add_u32 v62, 57344, v60
    v_add_u32 v63, 86016, v60
    s_lshl_b32 s67, s55, 13
    s_lshl_b32 s59, s54, 12
    s_add_u32 s67, s67, s59
    s_lshr_b32 s32, s49, 1
    s_lshl_b32 s32, s32, 9
    s_lshl_b32 s59, s48, 7
    s_add_u32 s32, s32, s59
    s_add_u32 s32, s32, 0x1304000
    s_waitcnt vmcnt(4)
    v_cmp_gt_u32 s[26:27], 8, v40
    s_cmp_eq_u64 s[26:27], 0
    s_cbranch_scc1 L_pvd_10
    s_mov_b32 s61, 30000
L_pv_9:
    s_sleep 2
    buffer_load_dword v40, v43, s[12:15], s68 offen sc1
    s_waitcnt vmcnt(0)
    v_cmp_gt_u32 s[26:27], 8, v40
    s_cmp_eq_u64 s[26:27], 0
    s_cbranch_scc1 L_pvd_10
    s_sub_u32 s61, s61, 1
    s_cmp_lg_u32 s61, 0
    s_cbranch_scc1 L_pv_9
    s_or_b32 s47, s47, 4
L_pvd_10:
    s_waitcnt vmcnt(3)
    v_cmp_gt_u32 s[26:27], 8, v41
    s_cmp_eq_u64 s[26:27], 0
    s_cbranch_scc1 L_pvd_12
    s_mov_b32 s61, 30000
L_pv_11:
    s_sleep 2
    buffer_load_dword v41, v44, s[12:15], s69 offen sc1
    s_waitcnt vmcnt(0)
    v_cmp_gt_u32 s[26:27], 8, v41
    s_cmp_eq_u64 s[26:27], 0
    s_cbranch_scc1 L_pvd_12
    s_sub_u32 s61, s61, 1
    s_cmp_lg_u32 s61, 0
    s_cbranch_scc1 L_pv_11
    s_or_b32 s47, s47, 8
L_pvd_12:
    s_mul_i32 s56, s2, 8320
    s_add_u32 s56, s56, s64
    s_add_u32 s57, s56, 0x400000
    s_add_u32 m0, s64, 0x20000
    s_nop 0
    buffer_load_dwordx4 v30, s[12:15], s57 offen sc1 lds
    buffer_load_dwordx4 v30, s[12:15], s57 offen offset:1024 sc1 lds
    s_add_u32 s57, s56, 0x900000
    buffer_load_dwordx4 v[68:71], v30, s[12:15], s57 offen sc1
    buffer_load_dwordx4 v[72:75], v30, s[12:15], s57 offen offset:1024 sc1
    s_add_u32 m0, s67, 0x0
    s_mul_i32 s65, s16, 56
    buffer_load_dwordx4 v60, s[28:31], s65 offen lds
    s_add_u32 m0, s67, 0x400
    s_nop 0
    buffer_load_dwordx4 v61, s[28:31], s65 offen lds
    s_add_u32 m0, s67, 0x800
    s_nop 0
    buffer_load_dwordx4 v62, s[28:31], s65 offen lds
    s_add_u32 m0, s67, 0xc00
    s_nop 0
    buffer_load_dwordx4 v63, s[28:31], s65 offen lds
    s_add_u32 m0, s67, 0x4000
    s_mul_i32 s65, s17, 56
    buffer_load_dwordx4 v60, s[28:31], s65 offen lds
    s_waitcnt vmcnt(9)
    s_atomic_add s80, s[12:13], s32
    s_mov_b32 s35, s33
    s_add_u32 m0, s67, 0x4400
    s_nop 0
    buffer_load_dwordx4 v61, s[28:31], s65 offen lds
    s_add_u32 m0, s67, 0x4800
    s_nop 0
    buffer_load_dwordx4 v62, s[28:31], s65 offen lds
    s_add_u32 m0, s67, 0x4c00
    s_nop 0
    buffer_load_dwordx4 v63, s[28:31], s65 offen lds
    s_and_b32 s70, s62, 15
    s_lshl_b32 s70, s70, 9
    s_lshl_b32 s59, s48, 7
    s_add_u32 s70, s70, s59
    s_add_u32 s70, s70, 0x1304000
    s_lshl_b32 s32, s62, 14
    s_lshl_b32 s59, s55, 12
    s_add_u32 s32, s32, s59
    s_lshl_b32 s59, s54, 11
    s_add_u32 s32, s32, s59
    s_add_u32 s32, s32, 0x1290000
    s_add_u32 s33, s32, 8192
    s_lshl_b32 s3, s55, 15
    s_lshl_b32 s59, s54, 11
    s_add_u32 s3, s3, s59
    s_lshl_b32 s45, s62, 17
    s_add_u32 s45, s45, s3
    s_add_u32 s45, s45, 0x200000
    v_add_u32 v56, s45, v30
    v_add_u32 v57, 0x10000, v56
    s_lshl_b32 s56, s55, 13
    s_lshl_b32 s59, s54, 6
    s_add_u32 s56, s56, s59
    v_lshl_or_b32 v46, v36, 9, v31
    v_xor_b32 v46, s56, v46
    v_add_u32 v47, 0x10000, v46
    s_add_u32 m0, s67, 0x8000
    s_mul_i32 s65, s18, 56
    buffer_load_dwordx4 v60, s[28:31], s65 offen lds
    v_bfe_u32 v4, v34, 2, 4
    v_lshlrev_b32 v4, 6, v4
    v_and_b32 v5, 3, v34
    v_lshl_or_b32 v4, v5, 3, v4
    v_add_u32 v4, 0x20000, v4
    s_waitcnt vmcnt(11)
    s_barrier
    ds_read_b64_tr_b16 v[208:209], v4 offset:0
    ds_read_b64_tr_b16 v[210:211], v4 offset:1024
    ds_read_b64_tr_b16 v[224:225], v4 offset:4096
    ds_read_b64_tr_b16 v[226:227], v4 offset:5120
    ds_read_b64_tr_b16 v[212:213], v4 offset:2048
    ds_read_b64_tr_b16 v[214:215], v4 offset:3072
    s_add_u32 m0, s67, 0x8400
    s_nop 0
    buffer_load_dwordx4 v61, s[28:31], s65 offen lds
    ds_read_b64_tr_b16 v[228:229], v4 offset:6144
    ds_read_b64_tr_b16 v[230:231], v4 offset:7168
    ds_read_b64_tr_b16 v[216:217], v4 offset:32
    ds_read_b64_tr_b16 v[218:219], v4 offset:1056
    ds_read_b64_tr_b16 v[232:233], v4 offset:4128
    ds_read_b64_tr_b16 v[234:235], v4 offset:5152
    ds_read_b64_tr_b16 v[220:221], v4 offset:2080
    ds_read_b64_tr_b16 v[222:223], v4 offset:3104
    ds_read_b64_tr_b16 v[236:237], v4 offset:6176
    ds_read_b64_tr_b16 v[238:239], v4 offset:7200
    s_lshl_b32 s56, s55, 10
    s_lshl3_add_u32 s56, s54, s56
    s_add_u32 s56, s56, 0x22000
    v_add_u32 v6, s56, v30
    s_add_u32 m0, s67, 0x8800
    s_nop 0
    buffer_load_dwordx4 v62, s[28:31], s65 offen lds
    v_add_u32 v5, 0x22000, v30
    s_waitcnt lgkmcnt(14)
    v_mfma_f32_16x16x32_bf16 v[120:123], v[208:211], v[136:139], 0
    s_waitcnt lgkmcnt(12)
    v_mfma_f32_16x16x32_bf16 v[120:123], v[224:227], v[144:147], v[120:123]
    s_waitcnt lgkmcnt(10)
    v_mfma_f32_16x16x32_bf16 v[120:123], v[212:215], v[140:143], v[120:123]
    s_waitcnt lgkmcnt(8)
    v_mfma_f32_16x16x32_bf16 v[120:123], v[228:231], v[148:151], v[120:123]
    s_add_u32 m0, s67, 0x8c00
    s_nop 0
    buffer_load_dwordx4 v63, s[28:31], s65 offen lds
    v_mfma_f32_16x16x32_bf16 v[128:131], v[224:227], v[136:139], 0
    v_mfma_f32_16x16x32_bf16 v[128:131], v[208:211], v[152:155], v[128:131]
    v_mfma_f32_16x16x32_bf16 v[128:131], v[228:231], v[140:143], v[128:131]
    v_mfma_f32_16x16x32_bf16 v[128:131], v[212:215], v[156:159], v[128:131]
    s_add_u32 m0, s67, 0xc000
    s_mul_i32 s65, s19, 56
    buffer_load_dwordx4 v60, s[28:31], s65 offen lds
    s_waitcnt lgkmcnt(6)
    v_mfma_f32_16x16x32_bf16 v[124:127], v[216:219], v[136:139], 0
    s_waitcnt lgkmcnt(4)
    v_mfma_f32_16x16x32_bf16 v[124:127], v[232:235], v[144:147], v[124:127]
    s_waitcnt lgkmcnt(2)
    v_mfma_f32_16x16x32_bf16 v[124:127], v[220:223], v[140:143], v[124:127]
    s_waitcnt lgkmcnt(0)
    v_mfma_f32_16x16x32_bf16 v[124:127], v[236:239], v[148:151], v[124:127]
    s_add_u32 m0, s67, 0xc400
    s_nop 0
    buffer_load_dwordx4 v61, s[28:31], s65 offen lds
    v_mfma_f32_16x16x32_bf16 v[132:135], v[232:235], v[136:139], 0
    v_mfma_f32_16x16x32_bf16 v[132:135], v[216:219], v[152:155], v[132:135]
    v_mfma_f32_16x16x32_bf16 v[132:135], v[236:239], v[140:143], v[132:135]
    v_mfma_f32_16x16x32_bf16 v[132:135], v[220:223], v[156:159], v[132:135]
    s_add_u32 m0, s67, 0xc800
    s_nop 0
    buffer_load_dwordx4 v62, s[28:31], s65 offen lds
    s_waitcnt vmcnt(15)
    v_lshlrev_b32 v208, 16, v68
    v_and_b32 v216, 0xffff0000, v68
    v_lshlrev_b32 v209, 16, v69
    v_and_b32 v217, 0xffff0000, v69
    v_lshlrev_b32 v210, 16, v70
    v_and_b32 v218, 0xffff0000, v70
    v_lshlrev_b32 v211, 16, v71
    v_and_b32 v219, 0xffff0000, v71
    v_lshlrev_b32 v212, 16, v72
    v_and_b32 v220, 0xffff0000, v72
    v_lshlrev_b32 v213, 16, v73
    v_and_b32 v221, 0xffff0000, v73
    v_lshlrev_b32 v214, 16, v74
    s_add_u32 m0, s67, 0xcc00
    s_nop 0
    buffer_load_dwordx4 v63, s[28:31], s65 offen lds
    v_and_b32 v222, 0xffff0000, v74
    v_lshlrev_b32 v215, 16, v75
    v_and_b32 v223, 0xffff0000, v75
    v_pk_mul_f32 v[240:241], v[120:121], v[80:81]
    v_pk_mul_f32 v[242:243], v[122:123], v[82:83]
    v_pk_mul_f32 v[248:249], v[128:129], v[80:81]
    v_pk_mul_f32 v[250:251], v[130:131], v[82:83]
    v_pk_fma_f32 v[240:241], v[128:129], v[88:89], v[240:241]
    v_pk_fma_f32 v[242:243], v[130:131], v[90:91], v[242:243]
    v_pk_fma_f32 v[248:249], v[120:121], v[88:89], v[248:249] neg_lo:[1,0,0] neg_hi:[1,0,0]
    v_pk_fma_f32 v[250:251], v[122:123], v[90:91], v[250:251] neg_lo:[1,0,0] neg_hi:[1,0,0]
    v_pk_mul_f32 v[244:245], v[124:125], v[84:85]
    v_pk_mul_f32 v[246:247], v[126:127], v[86:87]
    v_pk_mul_f32 v[252:253], v[132:133], v[84:85]
    s_add_u32 m0, s67, 0x10000
    s_mul_i32 s65, s20, 56
    buffer_load_dwordx4 v60, s[28:31], s65 offen lds
    v_pk_mul_f32 v[254:255], v[134:135], v[86:87]
    v_pk_fma_f32 v[244:245], v[132:133], v[92:93], v[244:245]
    v_pk_fma_f32 v[246:247], v[134:135], v[94:95], v[246:247]
    v_pk_fma_f32 v[252:253], v[124:125], v[92:93], v[252:253] neg_lo:[1,0,0] neg_hi:[1,0,0]
    v_pk_fma_f32 v[254:255], v[126:127], v[94:95], v[254:255] neg_lo:[1,0,0] neg_hi:[1,0,0]
    v_cvt_pk_bf16_f32 v96, v240, v241
    v_cvt_pk_bf16_f32 v97, v242, v243
    v_cvt_pk_bf16_f32 v98, v244, v245
    v_cvt_pk_bf16_f32 v99, v246, v247
    v_cvt_pk_bf16_f32 v100, v248, v249
    v_cvt_pk_bf16_f32 v101, v250, v251
    v_cvt_pk_bf16_f32 v102, v252, v253
    v_cvt_pk_bf16_f32 v103, v254, v255
    s_add_u32 m0, s67, 0x10400
    s_nop 0
    buffer_load_dwordx4 v61, s[28:31], s65 offen lds
    v_mfma_f32_16x16x32_bf16 v[120:123], v[160:163], v[96:99], 0
    v_mfma_f32_16x16x32_bf16 v[120:123], v[168:171], v[100:103], v[120:123]
    v_mfma_f32_16x16x32_bf16 v[128:131], v[160:163], v[100:103], 0
    v_mfma_f32_16x16x32_bf16 v[128:131], v[176:179], v[96:99], v[128:131]
    s_add_u32 m0, s67, 0x10800
    s_nop 0
    buffer_load_dwordx4 v62, s[28:31], s65 offen lds
    v_mfma_f32_16x16x32_bf16 v[124:127], v[164:167], v[96:99], 0
    v_mfma_f32_16x16x32_bf16 v[124:127], v[172:175], v[100:103], v[124:127]
    v_mfma_f32_16x16x32_bf16 v[132:135], v[164:167], v[100:103], 0
    v_mfma_f32_16x16x32_bf16 v[132:135], v[180:183], v[96:99], v[132:135]
    s_add_u32 m0, s67, 0x10c00
    s_nop 0
    buffer_load_dwordx4 v63, s[28:31], s65 offen lds
    v_pk_mul_f32 v[240:241], v[120:121], v[208:209]
    v_pk_mul_f32 v[242:243], v[122:123], v[210:211]
    v_pk_mul_f32 v[248:249], v[128:129], v[208:209]
    v_pk_mul_f32 v[250:251], v[130:131], v[210:211]
    v_pk_fma_f32 v[240:241], v[128:129], v[216:217], v[240:241] neg_lo:[1,0,0] neg_hi:[1,0,0]
    v_pk_fma_f32 v[242:243], v[130:131], v[218:219], v[242:243] neg_lo:[1,0,0] neg_hi:[1,0,0]
    v_pk_fma_f32 v[248:249], v[120:121], v[216:217], v[248:249]
    v_pk_fma_f32 v[250:251], v[122:123], v[218:219], v[250:251]
    v_pk_mul_f32 v[244:245], v[124:125], v[212:213]
    v_pk_mul_f32 v[246:247], v[126:127], v[214:215]
    v_pk_mul_f32 v[252:253], v[132:133], v[212:213]
    v_pk_mul_f32 v[254:255], v[134:135], v[214:215]
    v_pk_fma_f32 v[244:245], v[132:133], v[220:221], v[244:245] neg_lo:[1,0,0] neg_hi:[1,0,0]
    v_pk_fma_f32 v[246:247], v[134:135], v[222:223], v[246:247] neg_lo:[1,0,0] neg_hi:[1,0,0]
    s_add_u32 m0, s67, 0x14000
    s_mul_i32 s65, s21, 56
    buffer_load_dwordx4 v60, s[28:31], s65 offen lds
    v_pk_fma_f32 v[252:253], v[124:125], v[220:221], v[252:253]
    v_pk_fma_f32 v[254:255], v[126:127], v[222:223], v[254:255]
    v_cvt_pk_bf16_f32 v96, v240, v241
    v_cvt_pk_bf16_f32 v97, v242, v243
    v_cvt_pk_bf16_f32 v98, v244, v245
    v_cvt_pk_bf16_f32 v99, v246, v247
    v_cvt_pk_bf16_f32 v100, v248, v249
    v_cvt_pk_bf16_f32 v101, v250, v251
    v_cvt_pk_bf16_f32 v102, v252, v253
    v_cvt_pk_bf16_f32 v103, v254, v255
    v_mfma_f32_16x16x32_bf16 v[120:123], v[96:99], v[184:187], 0
    s_nop 0
    v_mfma_f32_16x16x32_bf16 v[120:123], v[100:103], v[200:203], v[120:123]
    s_add_u32 m0, s67, 0x14400
    s_nop 0
    buffer_load_dwordx4 v61, s[28:31], s65 offen lds
    v_mfma_f32_16x16x32_bf16 v[128:131], v[100:103], v[184:187], 0
    v_mfma_f32_16x16x32_bf16 v[128:131], v[96:99], v[192:195], v[128:131]
    v_mfma_f32_16x16x32_bf16 v[124:127], v[96:99], v[188:191], 0
    v_mfma_f32_16x16x32_bf16 v[124:127], v[100:103], v[204:207], v[124:127]
    s_add_u32 m0, s67, 0x14800
    s_nop 0
    buffer_load_dwordx4 v62, s[28:31], s65 offen lds
    v_mfma_f32_16x16x32_bf16 v[132:135], v[100:103], v[188:191], 0
    v_mfma_f32_16x16x32_bf16 v[132:135], v[96:99], v[196:199], v[132:135]
    v_pk_mul_f32 v[240:241], v[120:121], v[104:105]
    v_pk_mul_f32 v[242:243], v[122:123], v[106:107]
    v_pk_mul_f32 v[248:249], v[128:129], v[104:105]
    v_pk_mul_f32 v[250:251], v[130:131], v[106:107]
    v_pk_fma_f32 v[240:241], v[128:129], v[112:113], v[240:241] neg_lo:[1,0,0] neg_hi:[1,0,0]
    v_pk_fma_f32 v[242:243], v[130:131], v[114:115], v[242:243] neg_lo:[1,0,0] neg_hi:[1,0,0]
    v_pk_fma_f32 v[248:249], v[120:121], v[112:113], v[248:249]
    v_pk_fma_f32 v[250:251], v[122:123], v[114:115], v[250:251]
    s_add_u32 m0, s67, 0x14c00
    s_nop 0
    buffer_load_dwordx4 v63, s[28:31], s65 offen lds
    v_pk_mul_f32 v[244:245], v[124:125], v[108:109]
    v_pk_mul_f32 v[246:247], v[126:127], v[110:111]
    v_pk_mul_f32 v[252:253], v[132:133], v[108:109]
    v_pk_mul_f32 v[254:255], v[134:135], v[110:111]
    v_pk_fma_f32 v[244:245], v[132:133], v[116:117], v[244:245] neg_lo:[1,0,0] neg_hi:[1,0,0]
    v_pk_fma_f32 v[246:247], v[134:135], v[118:119], v[246:247] neg_lo:[1,0,0] neg_hi:[1,0,0]
    v_pk_fma_f32 v[252:253], v[124:125], v[116:117], v[252:253]
    v_pk_fma_f32 v[254:255], v[126:127], v[118:119], v[254:255]
    v_cvt_pk_bf16_f32 v96, v240, v241
    v_cvt_pk_bf16_f32 v97, v242, v243
    v_cvt_pk_bf16_f32 v98, v244, v245
    v_cvt_pk_bf16_f32 v99, v246, v247
    v_cvt_pk_bf16_f32 v100, v248, v249
    v_cvt_pk_bf16_f32 v101, v250, v251
    s_add_u32 m0, s67, 0x18000
    s_mul_i32 s65, s22, 56
    buffer_load_dwordx4 v60, s[28:31], s65 offen lds
    v_cvt_pk_bf16_f32 v102, v252, v253
    v_cvt_pk_bf16_f32 v103, v254, v255
    ds_write_b64 v6, v[96:97] offset:0
    ds_write_b64 v6, v[98:99] offset:4096
    ds_write_b64 v6, v[100:101] offset:2048
    ds_write_b64 v6, v[102:103] offset:6144
    s_waitcnt vmcnt(9) lgkmcnt(0)
    s_barrier
    s_load_dword s60, s[12:13], s70 glc
    s_add_u32 m0, s67, 0x18400
    s_nop 0
    buffer_load_dwordx4 v61, s[28:31], s65 offen lds
    ds_read_b128 v[208:211], v5 offset:0
    ds_read_b128 v[224:227], v5 offset:2048
    ds_read_b128 v[212:215], v5 offset:1024
    ds_read_b128 v[228:231], v5 offset:3072
    ds_read_b128 v[216:219], v5 offset:4096
    ds_read_b128 v[232:235], v5 offset:6144
    ds_read_b128 v[220:223], v5 offset:5120
    ds_read_b128 v[236:239], v5 offset:7168
    s_add_u32 m0, s67, 0x18800
    s_nop 0
    buffer_load_dwordx4 v62, s[28:31], s65 offen lds
    v_and_b32 v4, 15, v34
    v_lshlrev_b32 v4, 6, v4
    v_bfe_u32 v7, v34, 4, 1
    v_lshl_or_b32 v4, v7, 5, v4
    v_lshl_or_b32 v4, v36, 4, v4
    s_mul_i32 s57, s2, 8320
    s_lshl_b32 s56, s48, 10
    s_add_u32 s56, s56, s57
    s_add_u32 m0, s67, 0x18c00
    s_nop 0
    buffer_load_dwordx4 v63, s[28:31], s65 offen lds
    s_add_u32 s56, s56, 0x680000
    s_add_u32 s57, s56, 4096
    s_waitcnt lgkmcnt(7)
    v_mfma_f32_16x16x32_bf16 v[120:123], v[208:211], v[136:139], 0
    s_waitcnt lgkmcnt(6)
    ds_read_b64_tr_b16 a[0:1], v46 offset:0
    ds_read_b64_tr_b16 a[2:3], v46 offset:1024
    s_add_u32 m0, s67, 0x1c000
    s_mul_i32 s65, s23, 56
    buffer_load_dwordx4 v60, s[28:31], s65 offen lds
    v_mfma_f32_16x16x32_bf16 v[120:123], v[224:227], v[152:155], v[120:123]
    s_waitcnt lgkmcnt(7)
    ds_read_b64_tr_b16 a[4:5], v46 offset:2048
    ds_read_b64_tr_b16 a[6:7], v46 offset:3072
    v_mfma_f32_16x16x32_bf16 v[120:123], v[212:215], v[140:143], v[120:123]
    s_add_u32 m0, s67, 0x1c400
    s_nop 0
    buffer_load_dwordx4 v61, s[28:31], s65 offen lds
    s_waitcnt lgkmcnt(8)
    ds_read_b64_tr_b16 a[8:9], v46 offset:4096
    ds_read_b64_tr_b16 a[10:11], v46 offset:5120
    v_mfma_f32_16x16x32_bf16 v[120:123], v[228:231], v[156:159], v[120:123]
    ds_read_b64_tr_b16 a[12:13], v46 offset:6144
    ds_read_b64_tr_b16 a[14:15], v46 offset:7168
    s_add_u32 m0, s67, 0x1c800
    s_nop 0
    buffer_load_dwordx4 v62, s[28:31], s65 offen lds
    ds_read_b64_tr_b16 a[16:17], v46 offset:16384
    v_mfma_f32_16x16x32_bf16 v[128:131], v[224:227], v[136:139], 0
    ds_read_b64_tr_b16 a[18:19], v46 offset:17408
    ds_read_b64_tr_b16 a[20:21], v46 offset:18432
    v_mfma_f32_16x16x32_bf16 v[128:131], v[208:211], v[144:147], v[128:131]
    s_add_u32 m0, s67, 0x1cc00
    s_nop 0
    buffer_load_dwordx4 v63, s[28:31], s65 offen lds
    ds_read_b64_tr_b16 a[22:23], v46 offset:19456
    ds_read_b64_tr_b16 a[24:25], v46 offset:20480
    v_mfma_f32_16x16x32_bf16 v[128:131], v[228:231], v[140:143], v[128:131]
    ds_read_b64_tr_b16 a[26:27], v46 offset:21504
    ds_read_b64_tr_b16 a[28:29], v46 offset:22528
    v_mfma_f32_16x16x32_bf16 v[128:131], v[212:215], v[148:151], v[128:131]
    s_waitcnt lgkmcnt(14)
    ds_read_b64_tr_b16 a[30:31], v46 offset:23552
    ds_read_b64_tr_b16 a[32:33], v46 offset:32768
    v_mfma_f32_16x16x32_bf16 v[124:127], v[216:219], v[136:139], 0
    ds_read_b64_tr_b16 a[34:35], v46 offset:33792
    ds_read_b64_tr_b16 a[36:37], v46 offset:34816
    v_mfma_f32_16x16x32_bf16 v[124:127], v[232:235], v[152:155], v[124:127]
    ds_read_b64_tr_b16 a[38:39], v46 offset:35840
    ds_read_b64_tr_b16 a[40:41], v46 offset:36864
    v_mfma_f32_16x16x32_bf16 v[124:127], v[220:223], v[140:143], v[124:127]
    ds_read_b64_tr_b16 a[42:43], v46 offset:37888
    ds_read_b64_tr_b16 a[44:45], v46 offset:38912
    v_mfma_f32_16x16x32_bf16 v[124:127], v[236:239], v[156:159], v[124:127]
    ds_read_b64_tr_b16 a[46:47], v46 offset:39936
    ds_read_b64_tr_b16 a[48:49], v46 offset:49152
    ds_read_b64_tr_b16 a[50:51], v46 offset:50176
    v_mfma_f32_16x16x32_bf16 v[132:135], v[232:235], v[136:139], 0
    ds_read_b64_tr_b16 a[52:53], v46 offset:51200
    ds_read_b64_tr_b16 a[54:55], v46 offset:52224
    v_mfma_f32_16x16x32_bf16 v[132:135], v[216:219], v[144:147], v[132:135]
    ds_read_b64_tr_b16 a[56:57], v46 offset:53248
    ds_read_b64_tr_b16 a[58:59], v46 offset:54272
    v_mfma_f32_16x16x32_bf16 v[132:135], v[236:239], v[140:143], v[132:135]
    ds_read_b64_tr_b16 a[60:61], v46 offset:55296
    ds_read_b64_tr_b16 a[62:63], v46 offset:56320
    v_mfma_f32_16x16x32_bf16 v[132:135], v[220:223], v[148:151], v[132:135]
    v_cvt_pk_bf16_f32 v96, v120, v121
    v_cvt_pk_bf16_f32 v97, v122, v123
    v_cvt_pk_bf16_f32 v98, v124, v125
    v_cvt_pk_bf16_f32 v99, v126, v127
    v_cvt_pk_bf16_f32 v100, v128, v129
    v_cvt_pk_bf16_f32 v101, v130, v131
    s_nop 1
    v_cvt_pk_bf16_f32 v102, v132, v133
    v_cvt_pk_bf16_f32 v103, v134, v135
    v_permlane16_swap_b32 v96, v98
    v_permlane16_swap_b32 v97, v99
    v_permlane16_swap_b32 v100, v102
    v_permlane16_swap_b32 v101, v103
    s_waitcnt vmcnt(0)
    s_waitcnt lgkmcnt(0)
    s_cmp_ge_u32 s60, 16
    s_cbranch_scc1 L_psd_15
    s_mov_b32 s61, 30000
L_ps_14:
    s_load_dword s60, s[12:13], s70 glc
    s_waitcnt lgkmcnt(0)
    s_cmp_ge_u32 s60, 16
    s_cbranch_scc1 L_psd_15
    s_sub_u32 s61, s61, 1
    s_cmp_lg_u32 s61, 0
    s_cbranch_scc1 L_ps_14
    s_or_b32 s47, s47, 64
L_psd_15:
    s_barrier
    s_add_u32 m0, s3, 0x0
    s_nop 0
    buffer_load_dwordx4 v56, s[12:15], s16 offen sc1 lds
    ds_read_b64_tr_b16 a[64:65], v47 offset:0
    v_mfma_f32_4x4x4_16b_bf16 v[60:63], v[2:3], a[0:1], 0
    ds_read_b64_tr_b16 a[66:67], v47 offset:1024
    s_add_u32 m0, s3, 0x0
    s_nop 0
    buffer_load_dwordx4 v56, s[12:15], s16 offen offset:1024 sc1 lds
    v_mfma_f32_4x4x4_16b_bf16 v[64:67], v[2:3], a[2:3], 0
    ds_read_b64_tr_b16 a[68:69], v47 offset:2048
    v_mfma_f32_4x4x4_16b_bf16 v[60:63], v[2:3], a[4:5], v[60:63]
    buffer_load_dwordx4 v[80:83], v30, s[12:15], s32 offen sc1
    ds_read_b64_tr_b16 a[70:71], v47 offset:3072
    v_mfma_f32_4x4x4_16b_bf16 v[64:67], v[2:3], a[6:7], v[64:67]
    ds_read_b64_tr_b16 a[72:73], v47 offset:4096
    v_mfma_f32_4x4x4_16b_bf16 v[60:63], v[2:3], a[8:9], v[60:63]
    buffer_load_dwordx4 v[84:87], v30, s[12:15], s32 offen offset:1024 sc1
    ds_read_b64_tr_b16 a[74:75], v47 offset:5120
    v_mfma_f32_4x4x4_16b_bf16 v[64:67], v[2:3], a[10:11], v[64:67]
    ds_read_b64_tr_b16 a[76:77], v47 offset:6144
    v_mfma_f32_4x4x4_16b_bf16 v[60:63], v[2:3], a[12:13], v[60:63]
    buffer_load_dwordx4 v[88:91], v30, s[12:15], s33 offen sc1
    ds_read_b64_tr_b16 a[78:79], v47 offset:7168
    v_mfma_f32_4x4x4_16b_bf16 v[64:67], v[2:3], a[14:15], v[64:67]
    ds_read_b64_tr_b16 a[80:81], v47 offset:16384
    v_mfma_f32_4x4x4_16b_bf16 v[60:63], v[2:3], a[16:17], v[60:63]
    buffer_load_dwordx4 v[92:95], v30, s[12:15], s33 offen offset:1024 sc1
    ds_read_b64_tr_b16 a[82:83], v47 offset:17408
    v_mfma_f32_4x4x4_16b_bf16 v[64:67], v[2:3], a[18:19], v[64:67]
    ds_read_b64_tr_b16 a[84:85], v47 offset:18432
    v_mfma_f32_4x4x4_16b_bf16 v[60:63], v[2:3], a[20:21], v[60:63]
    s_add_u32 m0, s3, 0x1000
    s_nop 0
    buffer_load_dwordx4 v56, s[12:15], s17 offen sc1 lds
    ds_read_b64_tr_b16 a[86:87], v47 offset:19456
    v_mfma_f32_4x4x4_16b_bf16 v[64:67], v[2:3], a[22:23], v[64:67]
    ds_read_b64_tr_b16 a[88:89], v47 offset:20480
    s_add_u32 m0, s3, 0x1000
    s_nop 0
    buffer_load_dwordx4 v56, s[12:15], s17 offen offset:1024 sc1 lds
    v_mfma_f32_4x4x4_16b_bf16 v[60:63], v[2:3], a[24:25], v[60:63]
    ds_read_b64_tr_b16 a[90:91], v47 offset:21504
    v_mfma_f32_4x4x4_16b_bf16 v[64:67], v[2:3], a[26:27], v[64:67]
    s_add_u32 m0, s3, 0x2000
    s_nop 0
    buffer_load_dwordx4 v56, s[12:15], s18 offen sc1 lds
    ds_read_b64_tr_b16 a[92:93], v47 offset:22528
    v_mfma_f32_4x4x4_16b_bf16 v[60:63], v[2:3], a[28:29], v[60:63]
    ds_read_b64_tr_b16 a[94:95], v47 offset:23552
    s_add_u32 m0, s3, 0x2000
    s_nop 0
    buffer_load_dwordx4 v56, s[12:15], s18 offen offset:1024 sc1 lds
    v_mfma_f32_4x4x4_16b_bf16 v[64:67], v[2:3], a[30:31], v[64:67]
    ds_read_b64_tr_b16 a[96:97], v47 offset:32768
    v_mfma_f32_4x4x4_16b_bf16 v[60:63], v[2:3], a[32:33], v[60:63]
    buffer_store_dwordx4 v[96:99], v4, s[12:15], s56 offen sc1
    buffer_store_dwordx4 v[100:103], v4, s[12:15], s57 offen sc1
    ds_read_b64_tr_b16 a[98:99], v47 offset:33792
    v_mfma_f32_4x4x4_16b_bf16 v[64:67], v[2:3], a[34:35], v[64:67]
    ds_read_b64_tr_b16 a[100:101], v47 offset:34816
    s_add_u32 m0, s3, 0x3000
    s_nop 0
    buffer_load_dwordx4 v56, s[12:15], s19 offen sc1 lds
    v_mfma_f32_4x4x4_16b_bf16 v[60:63], v[2:3], a[36:37], v[60:63]
    ds_read_b64_tr_b16 a[102:103], v47 offset:35840
    v_mfma_f32_4x4x4_16b_bf16 v[64:67], v[2:3], a[38:39], v[64:67]
    s_add_u32 m0, s3, 0x3000
    s_nop 0
    buffer_load_dwordx4 v56, s[12:15], s19 offen offset:1024 sc1 lds
    ds_read_b64_tr_b16 a[104:105], v47 offset:36864
    v_mfma_f32_4x4x4_16b_bf16 v[60:63], v[2:3], a[40:41], v[60:63]
    ds_read_b64_tr_b16 a[106:107], v47 offset:37888
    s_add_u32 m0, s3, 0x4000
    s_nop 0
    buffer_load_dwordx4 v56, s[12:15], s20 offen sc1 lds
    v_mfma_f32_4x4x4_16b_bf16 v[64:67], v[2:3], a[42:43], v[64:67]
    ds_read_b64_tr_b16 a[108:109], v47 offset:38912
    v_mfma_f32_4x4x4_16b_bf16 v[60:63], v[2:3], a[44:45], v[60:63]
    s_add_u32 m0, s3, 0x4000
    s_nop 0
    buffer_load_dwordx4 v56, s[12:15], s20 offen offset:1024 sc1 lds
    ds_read_b64_tr_b16 a[110:111], v47 offset:39936
    v_mfma_f32_4x4x4_16b_bf16 v[64:67], v[2:3], a[46:47], v[64:67]
    ds_read_b64_tr_b16 a[112:113], v47 offset:49152
    v_mfma_f32_4x4x4_16b_bf16 v[60:63], v[2:3], a[48:49], v[60:63]
    ds_read_b64_tr_b16 a[114:115], v47 offset:50176
    v_mfma_f32_4x4x4_16b_bf16 v[64:67], v[2:3], a[50:51], v[64:67]
    ds_read_b64_tr_b16 a[116:117], v47 offset:51200
    v_mfma_f32_4x4x4_16b_bf16 v[60:63], v[2:3], a[52:53], v[60:63]
    ds_read_b64_tr_b16 a[118:119], v47 offset:52224
    v_mfma_f32_4x4x4_16b_bf16 v[64:67], v[2:3], a[54:55], v[64:67]
    ds_read_b64_tr_b16 a[120:121], v47 offset:53248
    v_mfma_f32_4x4x4_16b_bf16 v[60:63], v[2:3], a[56:57], v[60:63]
    ds_read_b64_tr_b16 a[122:123], v47 offset:54272
    v_mfma_f32_4x4x4_16b_bf16 v[64:67], v[2:3], a[58:59], v[64:67]
    ds_read_b64_tr_b16 a[124:125], v47 offset:55296
    v_mfma_f32_4x4x4_16b_bf16 v[60:63], v[2:3], a[60:61], v[60:63]
    ds_read_b64_tr_b16 a[126:127], v47 offset:56320
    v_mfma_f32_4x4x4_16b_bf16 v[64:67], v[2:3], a[62:63], v[64:67]
    s_waitcnt lgkmcnt(14)
    v_mfma_f32_4x4x4_16b_bf16 v[60:63], v[2:3], a[64:65], v[60:63]
    v_mfma_f32_4x4x4_16b_bf16 v[64:67], v[2:3], a[66:67], v[64:67]
    s_nop 0
    v_mfma_f32_4x4x4_16b_bf16 v[60:63], v[2:3], a[68:69], v[60:63]
    v_mfma_f32_4x4x4_16b_bf16 v[64:67], v[2:3], a[70:71], v[64:67]
    s_nop 0
    v_mfma_f32_4x4x4_16b_bf16 v[60:63], v[2:3], a[72:73], v[60:63]
    v_mfma_f32_4x4x4_16b_bf16 v[64:67], v[2:3], a[74:75], v[64:67]
    s_nop 0
    v_mfma_f32_4x4x4_16b_bf16 v[60:63], v[2:3], a[76:77], v[60:63]
    v_mfma_f32_4x4x4_16b_bf16 v[64:67], v[2:3], a[78:79], v[64:67]
    s_nop 0
    v_mfma_f32_4x4x4_16b_bf16 v[60:63], v[2:3], a[80:81], v[60:63]
    v_mfma_f32_4x4x4_16b_bf16 v[64:67], v[2:3], a[82:83], v[64:67]
    s_nop 0
    v_mfma_f32_4x4x4_16b_bf16 v[60:63], v[2:3], a[84:85], v[60:63]
    v_mfma_f32_4x4x4_16b_bf16 v[64:67], v[2:3], a[86:87], v[64:67]
    s_nop 0
    v_mfma_f32_4x4x4_16b_bf16 v[60:63], v[2:3], a[88:89], v[60:63]
    v_mfma_f32_4x4x4_16b_bf16 v[64:67], v[2:3], a[90:91], v[64:67]
    s_nop 0
    v_mfma_f32_4x4x4_16b_bf16 v[60:63], v[2:3], a[92:93], v[60:63]
    v_mfma_f32_4x4x4_16b_bf16 v[64:67], v[2:3], a[94:95], v[64:67]
    s_waitcnt lgkmcnt(8)
    v_mfma_f32_4x4x4_16b_bf16 v[60:63], v[2:3], a[96:97], v[60:63]
    v_mfma_f32_4x4x4_16b_bf16 v[64:67], v[2:3], a[98:99], v[64:67]
    s_nop 0
    v_mfma_f32_4x4x4_16b_bf16 v[60:63], v[2:3], a[100:101], v[60:63]
    v_mfma_f32_4x4x4_16b_bf16 v[64:67], v[2:3], a[102:103], v[64:67]
    s_nop 0
    v_mfma_f32_4x4x4_16b_bf16 v[60:63], v[2:3], a[104:105], v[60:63]
    v_mfma_f32_4x4x4_16b_bf16 v[64:67], v[2:3], a[106:107], v[64:67]
    s_nop 0
    v_mfma_f32_4x4x4_16b_bf16 v[60:63], v[2:3], a[108:109], v[60:63]
    v_mfma_f32_4x4x4_16b_bf16 v[64:67], v[2:3], a[110:111], v[64:67]
    s_waitcnt lgkmcnt(0)
    v_mfma_f32_4x4x4_16b_bf16 v[60:63], v[2:3], a[112:113], v[60:63]
    v_mfma_f32_4x4x4_16b_bf16 v[64:67], v[2:3], a[114:115], v[64:67]
    s_nop 0
    v_mfma_f32_4x4x4_16b_bf16 v[60:63], v[2:3], a[116:117], v[60:63]
    v_mfma_f32_4x4x4_16b_bf16 v[64:67], v[2:3], a[118:119], v[64:67]
    s_nop 0
    v_mfma_f32_4x4x4_16b_bf16 v[60:63], v[2:3], a[120:121], v[60:63]
    v_mfma_f32_4x4x4_16b_bf16 v[64:67], v[2:3], a[122:123], v[64:67]
    s_nop 0
    v_mfma_f32_4x4x4_16b_bf16 v[60:63], v[2:3], a[124:125], v[60:63]
    v_mfma_f32_4x4x4_16b_bf16 v[64:67], v[2:3], a[126:127], v[64:67]
    s_nop 4
    v_add_f32 v8, v60, v64
    v_cmp_eq_u32 vcc, 0, v36
    v_mov_b32 v9, v8
    v_mov_b32 v54, 0
    s_nop 0
    v_permlane32_swap_b32 v8, v9
    v_mov_b32 v55, 0
    v_add_f32 v8, v8, v9
    v_cvt_pk_bf16_f32 v9, v8, v8
    v_and_b32 v10, 0xffff0000, v9
    v_sub_f32 v10, v8, v10
    v_cvt_pk_bf16_f32 v10, v8, v10
    v_and_b32 v9, 0xffff, v9
    v_cndmask_b32 v52, 0, v10, vcc
    v_cndmask_b32 v53, 0, v9, vcc
    buffer_load_dword v41, v43, s[12:15], s35 offen sc1
    s_lshr_b32 s71, s2, 6
    s_lshl_b32 s71, s71, 10
    s_lshl_b32 s59, s48, 12
    s_add_u32 s71, s71, s59
    s_lshl_b32 s59, s53, 7
    s_add_u32 s71, s71, s59
    s_add_u32 s71, s71, 0x1314000
    v_and_b32 v8, 1, v37
    v_lshl_or_b32 v8, v8, 12, v39
    v_lshrrev_b32 v9, 1, v37
    s_mov_b32 s56, 8320
    v_mad_u32_u24 v45, v9, s56, v8
    s_mul_i32 s56, s48, 532480
    s_lshl_b32 s68, s49, 7
    s_add_u32 s68, s68, s56
    s_add_u32 s68, s68, 0x680000
    s_lshl_b32 s69, s48, 14
    s_lshr_b32 s46, s49, 3
    s_lshl_b32 s46, s46, 12
    s_lshl_b32 s59, s48, 10
    s_add_u32 s46, s46, s59
    s_add_u32 s46, s46, 0x1314000
    s_cmp_ge_u32 s52, 28
    s_cbranch_scc1 L_nop3_16
    s_waitcnt vmcnt(11)
    v_pk_add_f32 v[80:81], v[80:81], v[84:85]
    v_pk_add_f32 v[88:89], v[88:89], v[92:93]
    v_pk_add_f32 v[82:83], v[82:83], v[86:87]
    v_pk_add_f32 v[90:91], v[90:91], v[94:95]
    v_and_b32 v4, 15, v34
    v_lshlrev_b32 v4, 4, v4
    v_bfe_u32 v5, v34, 4, 1
    v_permlane16_swap_b32 v80, v88
    v_permlane16_swap_b32 v81, v89
    v_permlane16_swap_b32 v82, v90
    v_permlane16_swap_b32 v83, v91
    v_add_f32 v80, v80, v88
    v_add_f32 v81, v81, v89
    v_add_f32 v82, v82, v90
    v_add_f32 v83, v83, v91
    v_mov_b32 v88, v80
    v_mov_b32 v89, v81
    v_mov_b32 v90, v82
    v_mov_b32 v91, v83
    s_lshl_b32 s56, s54, 10
    s_lshl_b32 s59, s55, 8
    s_add_u32 s56, s56, s59
    s_add_u32 s56, s56, 0x24000
    v_lshl_or_b32 v4, v5, 9, v4
    v_add_u32 v4, s56, v4
    v_permlane32_swap_b32 v80, v88
    v_permlane32_swap_b32 v81, v89
    v_permlane32_swap_b32 v82, v90
    v_permlane32_swap_b32 v83, v91
    v_add_f32 v80, v80, v88
    v_add_f32 v81, v81, v89
    v_add_f32 v82, v82, v90
    v_add_f32 v83, v83, v91
    ds_write_b128 v4, v[80:83]
    v_lshlrev_b32 v4, 3, v35
    v_add_u32 v4, 0x24000, v4
    v_add_u32 v47, 0x10000, v30
    v_mov_b32 v46, v30
    s_mul_i32 s44, s62, 458752
    s_lshl_b32 s56, s63, 13
    s_lshl_b32 s59, s48, 11
    s_add_u32 s56, s56, s59
    s_add_u32 s56, s56, 0xb80000
    s_add_u32 s44, s44, s56
    s_lshl_b32 s24, s50, 6
    s_lshl_b32 s25, s54, 5
    s_add_u32 s24, s24, s25
    v_add_u32 v217, s24, v35
    v_xor_b32 v218, 32, v217
    s_lshl_b32 s24, s48, 6
    v_lshl_add_u32 v219, v36, 2, s24
    v_cmp_eq_u32 s[24:25], 0, v219
    v_cvt_f32_u32 v219, v219
    v_cvt_f32_u32 v200, v217
    v_mul_f32 v220, 0.5, v200
    v_mul_f32 v200, 0x3b000000, v200
    v_mul_f32 v202, v200, v219
    v_cndmask_b32 v204, v202, v220, s[24:25]
    v_cvt_f32_u32 v201, v218
    v_mul_f32 v220, 0.5, v201
    v_mul_f32 v201, 0x3b000000, v201
    v_mul_f32 v203, v201, v219
    v_cndmask_b32 v205, v203, v220, s[24:25]
    v_fmamk_f32 v208, v200, 0x00000000, v202
    v_fmamk_f32 v209, v200, 0x3f800000, v202
    v_fmamk_f32 v210, v200, 0x40000000, v202
    v_fmamk_f32 v211, v200, 0x40400000, v202
    v_cos_f32 v224, v208
    v_sin_f32 v225, v208
    v_cos_f32 v226, v209
    v_sin_f32 v227, v209
    v_cos_f32 v228, v210
    v_sin_f32 v229, v210
    v_cos_f32 v230, v211
    v_sin_f32 v231, v211
    v_cos_f32 v204, v204
    v_cvt_pk_bf16_f32 v211, v230, -v231
    v_cvt_pk_bf16_f32 v210, v228, -v229
    v_cvt_pk_bf16_f32 v209, v226, -v227
    v_cvt_pk_bf16_f32 v208, v204, -v225
    v_fmamk_f32 v212, v201, 0x00000000, v203
    v_fmamk_f32 v213, v201, 0x3f800000, v203
    v_fmamk_f32 v214, v201, 0x40000000, v203
    v_fmamk_f32 v215, v201, 0x40400000, v203
    s_add_u32 m0, s3, 0x5000
    s_nop 0
    buffer_load_dwordx4 v56, s[12:15], s21 offen sc1 lds
    s_waitcnt vmcnt(10)
    s_waitcnt lgkmcnt(0)
    s_barrier
    ds_read_b128 v[108:111], v46 offset:0
    ds_read_b128 v[112:115], v46 offset:1024
    ds_read_b128 v[116:119], v46 offset:2048
    ds_read_b128 v[120:123], v46 offset:3072
    ds_read_b128 v[124:127], v46 offset:4096
    s_waitcnt lgkmcnt(3)
    v_mfma_f32_32x32x16_bf16 v[132:147], a[0:3], v[108:111], 0
    ds_read_b128 v[128:131], v46 offset:5120
    ds_read_b64 v[80:81], v4 offset:0
    s_add_u32 m0, s3, 0x5000
    s_nop 0
    buffer_load_dwordx4 v56, s[12:15], s21 offen offset:1024 sc1 lds
    ds_read_b64 v[82:83], v4 offset:1024
    ds_read_b64 v[84:85], v4 offset:256
    v_mfma_f32_32x32x16_bf16 v[132:147], a[4:7], v[112:115], v[132:147]
    ds_read_b128 v[108:111], v46 offset:6144
    s_waitcnt lgkmcnt(6)
    ds_read_b64 v[86:87], v4 offset:1280
    ds_read_b64 v[88:89], v4 offset:512
    ds_read_b64 v[90:91], v4 offset:1536
    ds_read_b64 v[92:93], v4 offset:768
    v_mfma_f32_32x32x16_bf16 v[132:147], a[8:11], v[116:119], v[132:147]
    ds_read_b128 v[112:115], v46 offset:7168
    s_add_u32 m0, s3, 0x6000
    s_nop 0
    buffer_load_dwordx4 v56, s[12:15], s22 offen sc1 lds
    ds_read_b64 v[94:95], v4 offset:1792
    v_mov_b32 v104, 0
    v_mov_b32 v105, 0
    v_mfma_f32_32x32x16_bf16 v[132:147], a[12:15], v[120:123], v[132:147]
    s_waitcnt lgkmcnt(10)
    s_waitcnt lgkmcnt(0)
    v_add_f32 v80, v80, v82
    v_add_f32 v81, v81, v83
    v_mul_f32 v80, 0xbb000000, v80
    v_mul_f32 v81, 0x3b000000, v81
    v_mfma_f32_32x32x16_bf16 v[132:147], a[16:19], v[124:127], v[132:147]
    s_add_u32 m0, s3, 0x6000
    s_nop 0
    buffer_load_dwordx4 v56, s[12:15], s22 offen offset:1024 sc1 lds
    v_fma_f32 v81, -v80, v80, v81
    v_cvt_pk_bf16_f32 v96, v80, v80
    v_max_f32 v81, 0, v81
    v_and_b32 v82, 0xffff0000, v96
    v_mfma_f32_32x32x16_bf16 v[132:147], a[20:23], v[128:131], v[132:147]
    v_add_f32 v81, 0x3727c5ac, v81
    v_sub_f32 v82, v80, v82
    v_rsq_f32 v83, v81
    v_cvt_pk_bf16_f32 v97, v82, v82
    v_mfma_f32_32x32x16_bf16 v[132:147], a[24:27], v[108:111], v[132:147]
    s_add_u32 m0, s3, 0x7000
    s_nop 0
    buffer_load_dwordx4 v56, s[12:15], s23 offen sc1 lds
    v_mul_f32 v62, v81, v83
    v_mul_f32 v60, 0xc0135761, v83
    v_mul_f32 v83, v83, v83
    v_mul_f32 v83, 0x3d372713, v83
    v_mfma_f32_32x32x16_bf16 v[132:147], a[28:31], v[112:115], v[132:147]
    s_add_u32 m0, s3, 0x7000
    s_nop 0
    buffer_load_dwordx4 v56, s[12:15], s23 offen offset:1024 sc1 lds
    s_waitcnt vmcnt(9)
    s_barrier
    ds_read_b128 v[116:119], v46 offset:8192
    ds_read_b128 v[120:123], v46 offset:9216
    ds_read_b128 v[124:127], v46 offset:10240
    ds_read_b128 v[128:131], v46 offset:11264
    ds_read_b128 v[108:111], v46 offset:12288
    s_waitcnt lgkmcnt(3)
    v_mfma_f32_32x32x16_bf16 v[132:147], a[32:35], v[116:119], v[132:147]
    ds_read_b128 v[112:115], v46 offset:13312
    v_mul_f32 v61, v60, v83
    v_add_f32 v84, v84, v86
    s_add_u32 m0, s3, 0x10000
    s_nop 0
    buffer_load_dwordx4 v57, s[12:15], s16 offen sc1 lds
    v_add_f32 v85, v85, v87
    v_mfma_f32_32x32x16_bf16 v[132:147], a[36:39], v[120:123], v[132:147]
    ds_read_b128 v[116:119], v46 offset:14336
    s_waitcnt lgkmcnt(3)
    v_mul_f32 v84, 0xbb000000, v84
    v_mul_f32 v85, 0x3b000000, v85
    v_fma_f32 v85, -v84, v84, v85
    v_cvt_pk_bf16_f32 v98, v84, v84
    v_mfma_f32_32x32x16_bf16 v[132:147], a[40:43], v[124:127], v[132:147]
    ds_read_b128 v[120:123], v46 offset:15360
    v_max_f32 v85, 0, v85
    s_add_u32 m0, s3, 0x10000
    s_nop 0
    buffer_load_dwordx4 v57, s[12:15], s16 offen offset:1024 sc1 lds
    v_and_b32 v86, 0xffff0000, v98
    v_add_f32 v85, 0x3727c5ac, v85
    v_mfma_f32_32x32x16_bf16 v[132:147], a[44:47], v[128:131], v[132:147]
    s_waitcnt lgkmcnt(2)
    v_sub_f32 v86, v84, v86
    v_rsq_f32 v87, v85
    v_cvt_pk_bf16_f32 v99, v86, v86
    v_mul_f32 v66, v85, v87
    v_mfma_f32_32x32x16_bf16 v[132:147], a[48:51], v[108:111], v[132:147]
    v_mul_f32 v64, 0xc0135761, v87
    s_add_u32 m0, s3, 0x11000
    s_nop 0
    buffer_load_dwordx4 v57, s[12:15], s17 offen sc1 lds
    v_mul_f32 v87, v87, v87
    v_mul_f32 v87, 0x3d372713, v87
    v_mul_f32 v65, v64, v87
    v_mfma_f32_32x32x16_bf16 v[132:147], a[52:55], v[112:115], v[132:147]
    s_waitcnt lgkmcnt(0)
    v_add_f32 v88, v88, v90
    v_add_f32 v89, v89, v91
    v_mul_f32 v88, 0xbb000000, v88
    v_mul_f32 v89, 0x3b000000, v89
    v_fma_f32 v89, -v88, v88, v89
    v_mfma_f32_32x32x16_bf16 v[132:147], a[56:59], v[116:119], v[132:147]
    s_add_u32 m0, s3, 0x11000
    s_nop 0
    buffer_load_dwordx4 v57, s[12:15], s17 offen offset:1024 sc1 lds
    v_cvt_pk_bf16_f32 v100, v88, v88
    v_max_f32 v89, 0, v89
    v_and_b32 v90, 0xffff0000, v100
    v_add_f32 v89, 0x3727c5ac, v89
    v_mfma_f32_32x32x16_bf16 v[132:147], a[60:63], v[120:123], v[132:147]
    s_add_u32 m0, s3, 0x12000
    s_nop 0
    buffer_load_dwordx4 v57, s[12:15], s18 offen sc1 lds
    s_waitcnt vmcnt(9)
    s_barrier
    ds_read_b128 v[124:127], v46 offset:16384
    ds_read_b128 v[128:131], v46 offset:17408
    ds_read_b128 v[108:111], v46 offset:18432
    ds_read_b128 v[112:115], v46 offset:19456
    ds_read_b128 v[116:119], v46 offset:20480
    s_waitcnt lgkmcnt(3)
    v_mfma_f32_32x32x16_bf16 v[132:147], a[64:67], v[124:127], v[132:147]
    ds_read_b128 v[120:123], v46 offset:21504
    v_sub_f32 v90, v88, v90
    v_rsq_f32 v91, v89
    s_add_u32 m0, s3, 0x12000
    s_nop 0
    buffer_load_dwordx4 v57, s[12:15], s18 offen offset:1024 sc1 lds
    v_mfma_f32_32x32x16_bf16 v[132:147], a[68:71], v[128:131], v[132:147]
    ds_read_b128 v[124:127], v46 offset:22528
    s_waitcnt lgkmcnt(3)
    v_cvt_pk_bf16_f32 v101, v90, v90
    v_mul_f32 v70, v89, v91
    v_mul_f32 v68, 0xc0135761, v91
    v_mul_f32 v91, v91, v91
    v_mfma_f32_32x32x16_bf16 v[132:147], a[72:75], v[108:111], v[132:147]
    ds_read_b128 v[128:131], v46 offset:23552
    v_mul_f32 v91, 0x3d372713, v91
    v_mul_f32 v69, v68, v91
    s_add_u32 m0, s3, 0x13000
    s_nop 0
    buffer_load_dwordx4 v57, s[12:15], s19 offen sc1 lds
    v_add_f32 v92, v92, v94
    v_mfma_f32_32x32x16_bf16 v[132:147], a[76:79], v[112:115], v[132:147]
    s_waitcnt lgkmcnt(2)
    v_add_f32 v93, v93, v95
    v_mul_f32 v92, 0xbb000000, v92
    v_mul_f32 v93, 0x3b000000, v93
    v_fma_f32 v93, -v92, v92, v93
    v_cvt_pk_bf16_f32 v102, v92, v92
    v_mfma_f32_32x32x16_bf16 v[132:147], a[80:83], v[116:119], v[132:147]
    v_max_f32 v93, 0, v93
    v_and_b32 v94, 0xffff0000, v102
    s_add_u32 m0, s3, 0x13000
    s_nop 0
    buffer_load_dwordx4 v57, s[12:15], s19 offen offset:1024 sc1 lds
    v_add_f32 v93, 0x3727c5ac, v93
    v_sub_f32 v94, v92, v94
    v_mfma_f32_32x32x16_bf16 v[132:147], a[84:87], v[120:123], v[132:147]
    s_waitcnt lgkmcnt(0)
    v_rsq_f32 v95, v93
    v_cvt_pk_bf16_f32 v103, v94, v94
    v_mul_f32 v74, v93, v95
    v_mul_f32 v72, 0xc0135761, v95
    v_mfma_f32_32x32x16_bf16 v[132:147], a[88:91], v[124:127], v[132:147]
    v_mul_f32 v95, v95, v95
    s_add_u32 m0, s3, 0x14000
    s_nop 0
    buffer_load_dwordx4 v57, s[12:15], s20 offen sc1 lds
    v_mul_f32 v95, 0x3d372713, v95
    v_mul_f32 v73, v72, v95
    v_mfma_f32_32x32x16_bf16 v[132:147], a[92:95], v[128:131], v[132:147]
    s_add_u32 m0, s3, 0x14000
    s_nop 0
    buffer_load_dwordx4 v57, s[12:15], s20 offen offset:1024 sc1 lds
    s_waitcnt vmcnt(10)
    s_barrier
    ds_read_b128 v[108:111], v46 offset:24576
    ds_read_b128 v[112:115], v46 offset:25600
    ds_read_b128 v[116:119], v46 offset:26624
    ds_read_b128 v[120:123], v46 offset:27648
    ds_read_b128 v[124:127], v46 offset:28672
    s_waitcnt lgkmcnt(3)
    v_mfma_f32_32x32x16_bf16 v[132:147], a[96:99], v[108:111], v[132:147]
    ds_read_b128 v[128:131], v46 offset:29696
    v_cos_f32 v232, v212
    s_add_u32 m0, s3, 0x15000
    s_nop 0
    buffer_load_dwordx4 v57, s[12:15], s21 offen sc1 lds
    v_mfma_f32_32x32x16_bf16 v[132:147], a[100:103], v[112:115], v[132:147]
    ds_read_b128 v[108:111], v46 offset:30720
    s_waitcnt lgkmcnt(3)
    v_sin_f32 v233, v212
    v_cos_f32 v234, v213
    v_mfma_f32_32x32x16_bf16 v[132:147], a[104:107], v[116:119], v[132:147]
    ds_read_b128 v[112:115], v46 offset:31744
    v_sin_f32 v235, v213
    s_add_u32 m0, s3, 0x15000
    s_nop 0
    buffer_load_dwordx4 v57, s[12:15], s21 offen offset:1024 sc1 lds
    v_mfma_f32_32x32x16_bf16 v[132:147], a[108:111], v[120:123], v[132:147]
    ds_read_b128 v[116:119], v46 offset:32768
    s_waitcnt lgkmcnt(3)
    v_cos_f32 v236, v214
    v_sin_f32 v237, v214
    v_mfma_f32_32x32x16_bf16 v[132:147], a[112:115], v[124:127], v[132:147]
    ds_read_b128 v[120:123], v46 offset:33792
    v_cos_f32 v238, v215
    s_add_u32 m0, s3, 0x16000
    s_nop 0
    buffer_load_dwordx4 v57, s[12:15], s22 offen sc1 lds
    v_mfma_f32_32x32x16_bf16 v[132:147], a[116:119], v[128:131], v[132:147]
    ds_read_b128 v[124:127], v46 offset:34816
    s_waitcnt lgkmcnt(3)
    v_sin_f32 v239, v215
    v_cos_f32 v205, v205
    v_mfma_f32_32x32x16_bf16 v[132:147], a[120:123], v[108:111], v[132:147]
    ds_read_b128 v[128:131], v46 offset:35840
    v_cvt_pk_bf16_f32 v215, v238, -v239
    s_add_u32 m0, s3, 0x16000
    s_nop 0
    buffer_load_dwordx4 v57, s[12:15], s22 offen offset:1024 sc1 lds
    v_cvt_pk_bf16_f32 v214, v236, -v237
    v_cvt_pk_bf16_f32 v213, v234, -v235
    v_mfma_f32_32x32x16_bf16 v[132:147], a[124:127], v[112:115], v[132:147]
    ds_read_b128 v[108:111], v46 offset:36864
    v_mfma_f32_32x32x16_bf16 v[132:147], v[52:55], v[96:99], v[132:147]
    s_add_u32 m0, s3, 0x17000
    s_nop 0
    buffer_load_dwordx4 v57, s[12:15], s23 offen sc1 lds
    v_cvt_pk_bf16_f32 v212, v205, -v233
    v_fmamk_f32 v216, v200, 0x41000000, v202
    v_fmamk_f32 v217, v200, 0x41100000, v202
    v_fmamk_f32 v218, v200, 0x41200000, v202
    v_fmamk_f32 v219, v200, 0x41300000, v202
    v_cos_f32 v240, v216
    v_sin_f32 v241, v216
    v_cos_f32 v242, v217
    v_sin_f32 v243, v217
    v_cos_f32 v244, v218
    s_add_u32 m0, s3, 0x17000
    s_nop 0
    buffer_load_dwordx4 v57, s[12:15], s23 offen offset:1024 sc1 lds
    v_sin_f32 v245, v218
    v_cos_f32 v246, v219
    v_sin_f32 v247, v219
    s_nop 0
    v_cvt_pk_bf16_f32 v219, v246, -v247
    v_cvt_pk_bf16_f32 v218, v244, -v245
    v_cvt_pk_bf16_f32 v217, v242, -v243
    v_cvt_pk_bf16_f32 v216, v240, -v241
    v_fmamk_f32 v220, v201, 0x41000000, v203
    v_fmamk_f32 v221, v201, 0x41100000, v203
    v_fmamk_f32 v222, v201, 0x41200000, v203
    v_fmamk_f32 v223, v201, 0x41300000, v203
    v_cmp_gt_u32 s[26:27], 7, v41
    s_cmp_eq_u64 s[26:27], 0
    s_cbranch_scc1 L_pvd_18
    s_mov_b32 s61, 30000
L_pv_17:
    s_sleep 2
    buffer_load_dword v41, v43, s[12:15], s35 offen sc1
    s_waitcnt vmcnt(0)
    v_cmp_gt_u32 s[26:27], 7, v41
    s_cmp_eq_u64 s[26:27], 0
    s_cbranch_scc1 L_pvd_18
    s_sub_u32 s61, s61, 1
    s_cmp_lg_u32 s61, 0
    s_cbranch_scc1 L_pv_17
    s_or_b32 s47, s47, 32
L_pvd_18:
    v_cos_f32 v248, v220
    s_lshl1_add_u32 s66, s4, 0
    buffer_load_dwordx4 a[128:131], v28, s[12:15], s66 offen sc1
    v_sin_f32 v249, v220
    v_cos_f32 v250, v221
    v_sin_f32 v251, v221
    v_cos_f32 v252, v222
    v_sin_f32 v253, v222
    v_cos_f32 v254, v223
    v_sin_f32 v255, v223
    buffer_load_dwordx4 a[132:135], v29, s[12:15], s66 offen sc1
    v_cvt_pk_bf16_f32 v223, v254, -v255
    v_cvt_pk_bf16_f32 v222, v252, -v253
    v_cvt_pk_bf16_f32 v221, v250, -v251
    v_cvt_pk_bf16_f32 v220, v248, -v249
    v_mul_f32 v200, 0x41000000, v200
    v_cos_f32 v200, v200
    v_mul_f32 v201, 0x41000000, v201
    v_cos_f32 v201, v201
    v_add_f32 v200, v200, v200
    v_add_f32 v201, v201, v201
    buffer_load_dwordx4 a[136:139], v28, s[12:15], s66 offen offset:2048 sc1
    s_waitcnt lgkmcnt(3)
    v_mfma_f32_32x32x16_bf16 v[148:163], a[0:3], v[116:119], 0
    ds_read_b128 v[112:115], v46 offset:37888
    v_mfma_f32_32x32x16_bf16 v[148:163], a[4:7], v[120:123], v[148:163]
    ds_read_b128 v[116:119], v46 offset:38912
    s_waitcnt lgkmcnt(3)
    v_mul_f32 v164, v132, v132
    v_mul_f32 v165, v133, v133
    v_mul_f32 v166, v134, v134
    v_mul_f32 v167, v135, v135
    v_fma_f32 v164, v164, v61, v60
    v_mfma_f32_32x32x16_bf16 v[148:163], a[8:11], v[124:127], v[148:163]
    buffer_load_dwordx4 a[140:143], v29, s[12:15], s66 offen offset:2048 sc1
    ds_read_b128 v[120:123], v46 offset:39936
    v_fma_f32 v165, v165, v61, v60
    v_fma_f32 v166, v166, v61, v60
    s_atomic_add s80, s[12:13], s71
    v_fma_f32 v167, v167, v61, v60
    v_mul_f32 v164, v164, v132
    v_mul_f32 v165, v165, v133
    v_mfma_f32_32x32x16_bf16 v[148:163], a[12:15], v[128:131], v[148:163]
    ds_read_b128 v[124:127], v46 offset:40960
    s_waitcnt lgkmcnt(3)
    v_mul_f32 v166, v166, v134
    v_mul_f32 v167, v167, v135
    v_exp_f32 v168, v164
    v_exp_f32 v169, v165
    v_mfma_f32_32x32x16_bf16 v[148:163], a[16:19], v[108:111], v[148:163]
    s_lshl1_add_u32 s66, s4, 4096
    buffer_load_dwordx4 a[144:147], v28, s[12:15], s66 offen sc1
    ds_read_b128 v[128:131], v46 offset:41984
    v_exp_f32 v170, v166
    v_exp_f32 v171, v167
    v_mfma_f32_32x32x16_bf16 v[148:163], a[20:23], v[112:115], v[148:163]
    ds_read_b128 v[108:111], v46 offset:43008
    s_waitcnt lgkmcnt(3)
    v_fma_f32 v168, v168, v62, v62
    v_fma_f32 v169, v169, v62, v62
    v_fma_f32 v170, v170, v62, v62
    v_fma_f32 v171, v171, v62, v62
    v_rcp_f32 v164, v168
    v_mfma_f32_32x32x16_bf16 v[148:163], a[24:27], v[116:119], v[148:163]
    ds_read_b128 v[112:115], v46 offset:44032
    buffer_load_dwordx4 a[148:151], v29, s[12:15], s66 offen sc1
    v_rcp_f32 v165, v169
    v_rcp_f32 v166, v170
    v_mfma_f32_32x32x16_bf16 v[148:163], a[28:31], v[120:123], v[148:163]
    ds_read_b128 v[116:119], v46 offset:45056
    s_waitcnt lgkmcnt(3)
    v_rcp_f32 v167, v171
    v_mul_f32 v132, v132, v164
    v_mul_f32 v133, v133, v165
    v_mul_f32 v134, v134, v166
    v_mfma_f32_32x32x16_bf16 v[148:163], a[32:35], v[124:127], v[148:163]
    ds_read_b128 v[120:123], v46 offset:46080
    v_mul_f32 v135, v135, v167
    v_cvt_pk_bf16_f32 v172, v132, v133
    v_cvt_pk_bf16_f32 v173, v134, v135
    buffer_load_dwordx4 a[152:155], v28, s[12:15], s66 offen offset:2048 sc1
    v_mul_f32 v164, v136, v136
    v_mul_f32 v165, v137, v137
    v_mfma_f32_32x32x16_bf16 v[148:163], a[36:39], v[128:131], v[148:163]
    ds_read_b128 v[124:127], v46 offset:47104
    s_waitcnt lgkmcnt(3)
    v_mul_f32 v166, v138, v138
    v_mul_f32 v167, v139, v139
    v_fma_f32 v164, v164, v61, v60
    v_fma_f32 v165, v165, v61, v60
    v_fma_f32 v166, v166, v61, v60
    v_mfma_f32_32x32x16_bf16 v[148:163], a[40:43], v[108:111], v[148:163]
    ds_read_b128 v[128:131], v46 offset:48128
    v_fma_f32 v167, v167, v61, v60
    v_mul_f32 v164, v164, v136
    v_mul_f32 v165, v165, v137
    v_mul_f32 v166, v166, v138
    v_mul_f32 v167, v167, v139
    buffer_load_dwordx4 a[156:159], v29, s[12:15], s66 offen offset:2048 sc1
    v_mfma_f32_32x32x16_bf16 v[148:163], a[44:47], v[112:115], v[148:163]
    ds_read_b128 v[108:111], v46 offset:49152
    s_waitcnt lgkmcnt(3)
    v_exp_f32 v168, v164
    v_exp_f32 v169, v165
    v_exp_f32 v170, v166
    v_mfma_f32_32x32x16_bf16 v[148:163], a[48:51], v[116:119], v[148:163]
    ds_read_b128 v[112:115], v46 offset:50176
    v_exp_f32 v171, v167
    v_fma_f32 v168, v168, v62, v62
    v_fma_f32 v169, v169, v62, v62
    v_mfma_f32_32x32x16_bf16 v[148:163], a[52:55], v[120:123], v[148:163]
    s_lshl1_add_u32 s66, s5, 0
    buffer_load_dwordx4 a[160:163], v28, s[12:15], s66 offen sc1
    ds_read_b128 v[116:119], v46 offset:51200
    s_waitcnt lgkmcnt(3)
    v_fma_f32 v170, v170, v62, v62
    v_fma_f32 v171, v171, v62, v62
    v_rcp_f32 v164, v168
    v_rcp_f32 v165, v169
    v_mfma_f32_32x32x16_bf16 v[148:163], a[56:59], v[124:127], v[148:163]
    ds_read_b128 v[120:123], v46 offset:52224
    v_rcp_f32 v166, v170
    v_rcp_f32 v167, v171
    v_mfma_f32_32x32x16_bf16 v[148:163], a[60:63], v[128:131], v[148:163]
    buffer_load_dwordx4 a[164:167], v29, s[12:15], s66 offen sc1
    ds_read_b128 v[124:127], v46 offset:53248
    s_waitcnt lgkmcnt(3)
    v_mul_f32 v136, v136, v164
    v_mul_f32 v137, v137, v165
    v_mul_f32 v138, v138, v166
    v_mul_f32 v139, v139, v167
    v_cvt_pk_bf16_f32 v174, v136, v137
    v_mfma_f32_32x32x16_bf16 v[148:163], a[64:67], v[108:111], v[148:163]
    ds_read_b128 v[128:131], v46 offset:54272
    v_cvt_pk_bf16_f32 v175, v138, v139
    v_mul_f32 v164, v140, v140
    v_mul_f32 v165, v141, v141
    v_mul_f32 v166, v142, v142
    v_mul_f32 v167, v143, v143
    v_mfma_f32_32x32x16_bf16 v[148:163], a[68:71], v[112:115], v[148:163]
    ds_read_b128 v[108:111], v46 offset:55296
    s_waitcnt lgkmcnt(3)
    buffer_load_dwordx4 a[168:171], v28, s[12:15], s66 offen offset:2048 sc1
    v_fma_f32 v164, v164, v61, v60
    v_fma_f32 v165, v165, v61, v60
    v_fma_f32 v166, v166, v61, v60
    v_fma_f32 v167, v167, v61, v60
    v_mul_f32 v164, v164, v140
    v_mfma_f32_32x32x16_bf16 v[148:163], a[72:75], v[116:119], v[148:163]
    ds_read_b128 v[112:115], v46 offset:56320
    v_mul_f32 v165, v165, v141
    v_mul_f32 v166, v166, v142
    v_mul_f32 v167, v167, v143
    v_exp_f32 v168, v164
    v_mfma_f32_32x32x16_bf16 v[148:163], a[76:79], v[120:123], v[148:163]
    ds_read_b128 v[116:119], v46 offset:57344
    s_waitcnt lgkmcnt(3)
    v_exp_f32 v169, v165
    buffer_load_dwordx4 a[172:175], v29, s[12:15], s66 offen offset:2048 sc1
    v_exp_f32 v170, v166
    v_exp_f32 v171, v167
    v_mfma_f32_32x32x16_bf16 v[148:163], a[80:83], v[124:127], v[148:163]
    ds_read_b128 v[120:123], v46 offset:58368
    v_fma_f32 v168, v168, v62, v62
    v_fma_f32 v169, v169, v62, v62
    v_fma_f32 v170, v170, v62, v62
    v_fma_f32 v171, v171, v62, v62
    v_mfma_f32_32x32x16_bf16 v[148:163], a[84:87], v[128:131], v[148:163]
    ds_read_b128 v[124:127], v46 offset:59392
    s_waitcnt lgkmcnt(3)
    v_rcp_f32 v164, v168
    v_rcp_f32 v165, v169
    s_lshl1_add_u32 s66, s5, 4096
    buffer_load_dwordx4 a[176:179], v28, s[12:15], s66 offen sc1
    v_rcp_f32 v166, v170
    v_mfma_f32_32x32x16_bf16 v[148:163], a[88:91], v[108:111], v[148:163]
    ds_read_b128 v[128:131], v46 offset:60416
    v_rcp_f32 v167, v171
    v_mul_f32 v140, v140, v164
    v_mul_f32 v141, v141, v165
    v_mfma_f32_32x32x16_bf16 v[148:163], a[92:95], v[112:115], v[148:163]
    ds_read_b128 v[108:111], v46 offset:61440
    s_waitcnt lgkmcnt(3)
    v_mul_f32 v142, v142, v166
    v_mul_f32 v143, v143, v167
    v_cvt_pk_bf16_f32 v176, v140, v141
    v_cvt_pk_bf16_f32 v177, v142, v143
    buffer_load_dwordx4 a[180:183], v29, s[12:15], s66 offen sc1
    v_mul_f32 v164, v144, v144
    v_mfma_f32_32x32x16_bf16 v[148:163], a[96:99], v[116:119], v[148:163]
    ds_read_b128 v[112:115], v46 offset:62464
    v_mul_f32 v165, v145, v145
    v_mul_f32 v166, v146, v146
    v_mul_f32 v167, v147, v147
    v_fma_f32 v164, v164, v61, v60
    v_fma_f32 v165, v165, v61, v60
    v_mfma_f32_32x32x16_bf16 v[148:163], a[100:103], v[120:123], v[148:163]
    ds_read_b128 v[116:119], v46 offset:63488
    s_waitcnt lgkmcnt(3)
    v_fma_f32 v166, v166, v61, v60
    v_fma_f32 v167, v167, v61, v60
    v_mul_f32 v164, v164, v144
    v_mul_f32 v165, v165, v145
    v_mul_f32 v166, v166, v146
    v_mfma_f32_32x32x16_bf16 v[148:163], a[104:107], v[124:127], v[148:163]
    buffer_load_dwordx4 a[184:187], v28, s[12:15], s66 offen offset:2048 sc1
    ds_read_b128 v[120:123], v46 offset:64512
    v_mul_f32 v167, v167, v147
    v_exp_f32 v168, v164
    v_exp_f32 v169, v165
    v_mfma_f32_32x32x16_bf16 v[148:163], a[108:111], v[128:131], v[148:163]
    s_waitcnt lgkmcnt(2)
    v_exp_f32 v170, v166
    v_exp_f32 v171, v167
    v_fma_f32 v168, v168, v62, v62
    v_mfma_f32_32x32x16_bf16 v[148:163], a[112:115], v[108:111], v[148:163]
    v_fma_f32 v169, v169, v62, v62
    v_fma_f32 v170, v170, v62, v62
    v_fma_f32 v171, v171, v62, v62
    buffer_load_dwordx4 a[188:191], v29, s[12:15], s66 offen offset:2048 sc1
    v_rcp_f32 v164, v168
    v_mfma_f32_32x32x16_bf16 v[148:163], a[116:119], v[112:115], v[148:163]
    s_waitcnt lgkmcnt(0)
    v_rcp_f32 v165, v169
    v_rcp_f32 v166, v170
    v_rcp_f32 v167, v171
    v_mfma_f32_32x32x16_bf16 v[148:163], a[120:123], v[116:119], v[148:163]
    v_mul_f32 v144, v144, v164
    v_mul_f32 v145, v145, v165
    v_mul_f32 v146, v146, v166
    v_mul_f32 v147, v147, v167
    v_mfma_f32_32x32x16_bf16 v[148:163], a[124:127], v[120:123], v[148:163]
    s_lshl1_add_u32 s66, s6, 0
    buffer_load_dwordx4 a[192:195], v28, s[12:15], s66 offen sc1
    v_cvt_pk_bf16_f32 v178, v144, v145
    v_cvt_pk_bf16_f32 v179, v146, v147
    buffer_store_dwordx4 v[172:175], v30, s[12:15], s44 offen sc1
    buffer_store_dwordx4 v[176:179], v30, s[12:15], s44 offen offset:1024 sc1
    s_add_u32 s44, s44, 114688
    v_mfma_f32_32x32x16_bf16 v[148:163], v[52:55], v[98:101], v[148:163]
    s_waitcnt vmcnt(19)
    s_barrier
    buffer_load_dwordx4 a[196:199], v29, s[12:15], s66 offen sc1
    ds_read_b128 v[124:127], v47 offset:0
    ds_read_b128 v[128:131], v47 offset:1024
    ds_read_b128 v[108:111], v47 offset:2048
    ds_read_b128 v[112:115], v47 offset:3072
    ds_read_b128 v[116:119], v47 offset:4096
    s_waitcnt lgkmcnt(3)
    v_mfma_f32_32x32x16_bf16 v[132:147], a[0:3], v[124:127], 0
    ds_read_b128 v[120:123], v47 offset:5120
    v_mfma_f32_32x32x16_bf16 v[132:147], a[4:7], v[128:131], v[132:147]
    ds_read_b128 v[124:127], v47 offset:6144
    s_waitcnt lgkmcnt(3)
    v_mul_f32 v164, v148, v148
    buffer_load_dwordx4 a[200:203], v28, s[12:15], s66 offen offset:2048 sc1
    v_mul_f32 v165, v149, v149
    v_mul_f32 v166, v150, v150
    v_mul_f32 v167, v151, v151
    v_fma_f32 v164, v164, v65, v64
    v_mfma_f32_32x32x16_bf16 v[132:147], a[8:11], v[108:111], v[132:147]
    ds_read_b128 v[128:131], v47 offset:7168
    v_fma_f32 v165, v165, v65, v64
    v_fma_f32 v166, v166, v65, v64
    v_fma_f32 v167, v167, v65, v64
    v_mul_f32 v164, v164, v148
    v_mul_f32 v165, v165, v149
    v_mfma_f32_32x32x16_bf16 v[132:147], a[12:15], v[112:115], v[132:147]
    ds_read_b128 v[108:111], v47 offset:8192
    s_waitcnt lgkmcnt(3)
    v_mul_f32 v166, v166, v150
    v_mul_f32 v167, v167, v151
    v_exp_f32 v168, v164
    buffer_load_dwordx4 a[204:207], v29, s[12:15], s66 offen offset:2048 sc1
    v_exp_f32 v169, v165
    v_mfma_f32_32x32x16_bf16 v[132:147], a[16:19], v[116:119], v[132:147]
    ds_read_b128 v[112:115], v47 offset:9216
    v_exp_f32 v170, v166
    v_exp_f32 v171, v167
    v_mfma_f32_32x32x16_bf16 v[132:147], a[20:23], v[120:123], v[132:147]
    ds_read_b128 v[116:119], v47 offset:10240
    s_waitcnt lgkmcnt(3)
    v_fma_f32 v168, v168, v66, v66
    v_fma_f32 v169, v169, v66, v66
    v_fma_f32 v170, v170, v66, v66
    v_fma_f32 v171, v171, v66, v66
    v_rcp_f32 v164, v168
    s_lshl1_add_u32 s66, s6, 4096
    buffer_load_dwordx4 a[208:211], v28, s[12:15], s66 offen sc1
    v_mfma_f32_32x32x16_bf16 v[132:147], a[24:27], v[124:127], v[132:147]
    ds_read_b128 v[120:123], v47 offset:11264
    v_rcp_f32 v165, v169
    v_rcp_f32 v166, v170
    v_mfma_f32_32x32x16_bf16 v[132:147], a[28:31], v[128:131], v[132:147]
    ds_read_b128 v[124:127], v47 offset:12288
    s_waitcnt lgkmcnt(3)
    v_rcp_f32 v167, v171
    v_mul_f32 v148, v148, v164
    v_mul_f32 v149, v149, v165
    v_mul_f32 v150, v150, v166
    v_mfma_f32_32x32x16_bf16 v[132:147], a[32:35], v[108:111], v[132:147]
    buffer_load_dwordx4 a[212:215], v29, s[12:15], s66 offen sc1
    ds_read_b128 v[128:131], v47 offset:13312
    v_mul_f32 v151, v151, v167
    v_cvt_pk_bf16_f32 v172, v148, v149
    v_cvt_pk_bf16_f32 v173, v150, v151
    v_mul_f32 v164, v152, v152
    v_mul_f32 v165, v153, v153
    v_mfma_f32_32x32x16_bf16 v[132:147], a[36:39], v[112:115], v[132:147]
    ds_read_b128 v[108:111], v47 offset:14336
    s_waitcnt lgkmcnt(3)
    v_mul_f32 v166, v154, v154
    v_mul_f32 v167, v155, v155
    v_fma_f32 v164, v164, v65, v64
    v_fma_f32 v165, v165, v65, v64
    v_fma_f32 v166, v166, v65, v64
    v_mfma_f32_32x32x16_bf16 v[132:147], a[40:43], v[116:119], v[132:147]
    ds_read_b128 v[112:115], v47 offset:15360
    v_fma_f32 v167, v167, v65, v64
    buffer_load_dwordx4 a[216:219], v28, s[12:15], s66 offen offset:2048 sc1
    v_mul_f32 v164, v164, v152
    v_mul_f32 v165, v165, v153
    v_mul_f32 v166, v166, v154
    v_mul_f32 v167, v167, v155
    v_mfma_f32_32x32x16_bf16 v[132:147], a[44:47], v[120:123], v[132:147]
    ds_read_b128 v[116:119], v47 offset:16384
    s_waitcnt lgkmcnt(3)
    v_exp_f32 v168, v164
    v_exp_f32 v169, v165
    v_exp_f32 v170, v166
    v_mfma_f32_32x32x16_bf16 v[132:147], a[48:51], v[124:127], v[132:147]
    ds_read_b128 v[120:123], v47 offset:17408
    v_exp_f32 v171, v167
    buffer_load_dwordx4 a[220:223], v29, s[12:15], s66 offen offset:2048 sc1
    v_fma_f32 v168, v168, v66, v66
    v_fma_f32 v169, v169, v66, v66
    v_mfma_f32_32x32x16_bf16 v[132:147], a[52:55], v[128:131], v[132:147]
    ds_read_b128 v[124:127], v47 offset:18432
    s_waitcnt lgkmcnt(3)
    v_fma_f32 v170, v170, v66, v66
    v_fma_f32 v171, v171, v66, v66
    v_rcp_f32 v164, v168
    v_rcp_f32 v165, v169
    v_mfma_f32_32x32x16_bf16 v[132:147], a[56:59], v[108:111], v[132:147]
    ds_read_b128 v[128:131], v47 offset:19456
    v_rcp_f32 v166, v170
    v_rcp_f32 v167, v171
    s_lshl1_add_u32 s66, s7, 0
    buffer_load_dwordx4 a[224:227], v28, s[12:15], s66 offen sc1
    v_mfma_f32_32x32x16_bf16 v[132:147], a[60:63], v[112:115], v[132:147]
    ds_read_b128 v[108:111], v47 offset:20480
    s_waitcnt lgkmcnt(3)
    v_mul_f32 v152, v152, v164
    v_mul_f32 v153, v153, v165
    v_mul_f32 v154, v154, v166
    v_mul_f32 v155, v155, v167
    v_cvt_pk_bf16_f32 v174, v152, v153
    v_mfma_f32_32x32x16_bf16 v[132:147], a[64:67], v[116:119], v[132:147]
    ds_read_b128 v[112:115], v47 offset:21504
    v_cvt_pk_bf16_f32 v175, v154, v155
    v_mul_f32 v164, v156, v156
    v_mul_f32 v165, v157, v157
    v_mul_f32 v166, v158, v158
    v_mul_f32 v167, v159, v159
    v_fma_f32 v164, v164, v65, v64
    buffer_load_dwordx4 a[228:231], v29, s[12:15], s66 offen sc1
    v_mfma_f32_32x32x16_bf16 v[132:147], a[68:71], v[120:123], v[132:147]
    ds_read_b128 v[116:119], v47 offset:22528
    s_waitcnt lgkmcnt(3)
    v_fma_f32 v165, v165, v65, v64
    v_fma_f32 v166, v166, v65, v64
    v_fma_f32 v167, v167, v65, v64
    v_mul_f32 v164, v164, v156
    v_mul_f32 v165, v165, v157
    v_mfma_f32_32x32x16_bf16 v[132:147], a[72:75], v[124:127], v[132:147]
    ds_read_b128 v[120:123], v47 offset:23552
    v_mul_f32 v166, v166, v158
    v_mul_f32 v167, v167, v159
    v_exp_f32 v168, v164
    v_mfma_f32_32x32x16_bf16 v[132:147], a[76:79], v[128:131], v[132:147]
    buffer_load_dwordx4 a[232:235], v28, s[12:15], s66 offen offset:2048 sc1
    ds_read_b128 v[124:127], v47 offset:24576
    s_waitcnt lgkmcnt(3)
    v_exp_f32 v169, v165
    v_exp_f32 v170, v166
    v_exp_f32 v171, v167
    v_mfma_f32_32x32x16_bf16 v[132:147], a[80:83], v[108:111], v[132:147]
    ds_read_b128 v[128:131], v47 offset:25600
    v_fma_f32 v168, v168, v66, v66
    v_fma_f32 v169, v169, v66, v66
    v_fma_f32 v170, v170, v66, v66
    v_fma_f32 v171, v171, v66, v66
    v_mfma_f32_32x32x16_bf16 v[132:147], a[84:87], v[112:115], v[132:147]
    ds_read_b128 v[108:111], v47 offset:26624
    buffer_load_dwordx4 a[236:239], v29, s[12:15], s66 offen offset:2048 sc1
    s_waitcnt lgkmcnt(3)
    v_rcp_f32 v164, v168
    v_rcp_f32 v165, v169
    buffer_load_dword v42, v44, s[12:15], s46 offen sc1
    v_mfma_f32_32x32x16_bf16 v[132:147], a[88:91], v[116:119], v[132:147]
    ds_read_b128 v[112:115], v47 offset:27648
    v_rcp_f32 v166, v170
    v_rcp_f32 v167, v171
    v_mul_f32 v156, v156, v164
    v_mul_f32 v157, v157, v165
    v_mfma_f32_32x32x16_bf16 v[132:147], a[92:95], v[120:123], v[132:147]
    ds_read_b128 v[116:119], v47 offset:28672
    s_waitcnt lgkmcnt(3)
    s_lshl1_add_u32 s66, s7, 4096
    buffer_load_dwordx4 a[240:243], v28, s[12:15], s66 offen sc1
    v_mul_f32 v158, v158, v166
    v_mul_f32 v159, v159, v167
    v_cvt_pk_bf16_f32 v176, v156, v157
    v_cvt_pk_bf16_f32 v177, v158, v159
    v_mul_f32 v164, v160, v160
    v_mfma_f32_32x32x16_bf16 v[132:147], a[96:99], v[124:127], v[132:147]
    ds_read_b128 v[120:123], v47 offset:29696
    v_mul_f32 v165, v161, v161
    v_mul_f32 v166, v162, v162
    v_mul_f32 v167, v163, v163
    v_fma_f32 v164, v164, v65, v64
    v_fma_f32 v165, v165, v65, v64
    v_mfma_f32_32x32x16_bf16 v[132:147], a[100:103], v[128:131], v[132:147]
    ds_read_b128 v[124:127], v47 offset:30720
    s_waitcnt lgkmcnt(3)
    v_fma_f32 v166, v166, v65, v64
    buffer_load_dwordx4 a[244:247], v29, s[12:15], s66 offen sc1
    v_fma_f32 v167, v167, v65, v64
    v_mul_f32 v164, v164, v160
    v_mul_f32 v165, v165, v161
    v_mul_f32 v166, v166, v162
    v_mfma_f32_32x32x16_bf16 v[132:147], a[104:107], v[108:111], v[132:147]
    ds_read_b128 v[128:131], v47 offset:31744
    v_mul_f32 v167, v167, v163
    v_exp_f32 v168, v164
    v_exp_f32 v169, v165
    v_mfma_f32_32x32x16_bf16 v[132:147], a[108:111], v[112:115], v[132:147]
    ds_read_b128 v[108:111], v47 offset:32768
    s_waitcnt lgkmcnt(3)
    v_exp_f32 v170, v166
    v_exp_f32 v171, v167
    buffer_load_dwordx4 a[248:251], v28, s[12:15], s66 offen offset:2048 sc1
    v_fma_f32 v168, v168, v66, v66
    v_mfma_f32_32x32x16_bf16 v[132:147], a[112:115], v[116:119], v[132:147]
    ds_read_b128 v[112:115], v47 offset:33792
    v_fma_f32 v169, v169, v66, v66
    v_fma_f32 v170, v170, v66, v66
    v_fma_f32 v171, v171, v66, v66
    v_rcp_f32 v164, v168
    v_mfma_f32_32x32x16_bf16 v[132:147], a[116:119], v[120:123], v[132:147]
    ds_read_b128 v[116:119], v47 offset:34816
    s_waitcnt lgkmcnt(3)
    v_rcp_f32 v165, v169
    v_rcp_f32 v166, v170
    v_mfma_f32_32x32x16_bf16 v[132:147], a[120:123], v[124:127], v[132:147]
    buffer_load_dwordx4 a[252:255], v29, s[12:15], s66 offen offset:2048 sc1
    ds_read_b128 v[120:123], v47 offset:35840
    v_rcp_f32 v167, v171
    v_mul_f32 v160, v160, v164
    v_mul_f32 v161, v161, v165
    v_mul_f32 v162, v162, v166
    v_mul_f32 v163, v163, v167
    v_mfma_f32_32x32x16_bf16 v[132:147], a[124:127], v[128:131], v[132:147]
    ds_read_b128 v[124:127], v47 offset:36864
    v_cvt_pk_bf16_f32 v178, v160, v161
    v_cvt_pk_bf16_f32 v179, v162, v163
    buffer_store_dwordx4 v[172:175], v30, s[12:15], s44 offen sc1
    buffer_store_dwordx4 v[176:179], v30, s[12:15], s44 offen offset:1024 sc1
    s_add_u32 s44, s44, 114688
    v_mfma_f32_32x32x16_bf16 v[132:147], v[52:55], v[100:103], v[132:147]
    s_waitcnt vmcnt(6)
    v_cmp_gt_u32 s[26:27], 8, v42
    s_cmp_eq_u64 s[26:27], 0
    s_cbranch_scc1 L_pvd_20
    s_mov_b32 s61, 30000
L_pv_19:
    s_sleep 2
    buffer_load_dword v42, v44, s[12:15], s46 offen sc1
    s_waitcnt vmcnt(0)
    v_cmp_gt_u32 s[26:27], 8, v42
    s_cmp_eq_u64 s[26:27], 0
    s_cbranch_scc1 L_pvd_20
    s_sub_u32 s61, s61, 1
    s_cmp_lg_u32 s61, 0
    s_cbranch_scc1 L_pv_19
    s_or_b32 s47, s47, 128
L_pvd_20:
    s_waitcnt lgkmcnt(3)
    s_add_u32 m0, s69, 0x0
    s_add_u32 s65, s68, 0
    buffer_load_dwordx4 v45, s[12:15], s65 offen sc1 lds
    v_mfma_f32_32x32x16_bf16 v[148:163], a[0:3], v[108:111], 0
    ds_read_b128 v[128:131], v47 offset:37888
    v_mfma_f32_32x32x16_bf16 v[148:163], a[4:7], v[112:115], v[148:163]
    ds_read_b128 v[108:111], v47 offset:38912
    s_waitcnt lgkmcnt(3)
    v_mul_f32 v164, v132, v132
    s_add_u32 m0, s69, 0x400
    s_add_u32 s65, s68, 33280
    buffer_load_dwordx4 v45, s[12:15], s65 offen sc1 lds
    v_mul_f32 v165, v133, v133
    v_mul_f32 v166, v134, v134
    v_mul_f32 v167, v135, v135
    v_fma_f32 v164, v164, v69, v68
    v_mfma_f32_32x32x16_bf16 v[148:163], a[8:11], v[116:119], v[148:163]
    ds_read_b128 v[112:115], v47 offset:39936
    v_fma_f32 v165, v165, v69, v68
    v_fma_f32 v166, v166, v69, v68
    v_fma_f32 v167, v167, v69, v68
    v_mul_f32 v164, v164, v132
    v_mul_f32 v165, v165, v133
    v_mfma_f32_32x32x16_bf16 v[148:163], a[12:15], v[120:123], v[148:163]
    s_add_u32 m0, s69, 0x800
    s_add_u32 s65, s68, 66560
    buffer_load_dwordx4 v45, s[12:15], s65 offen sc1 lds
    ds_read_b128 v[116:119], v47 offset:40960
    s_waitcnt lgkmcnt(3)
    v_mul_f32 v166, v166, v134
    v_mul_f32 v167, v167, v135
    v_exp_f32 v168, v164
    v_exp_f32 v169, v165
    v_mfma_f32_32x32x16_bf16 v[148:163], a[16:19], v[124:127], v[148:163]
    ds_read_b128 v[120:123], v47 offset:41984
    v_exp_f32 v170, v166
    s_add_u32 m0, s69, 0xc00
    s_add_u32 s65, s68, 99840
    buffer_load_dwordx4 v45, s[12:15], s65 offen sc1 lds
    v_exp_f32 v171, v167
    v_mfma_f32_32x32x16_bf16 v[148:163], a[20:23], v[128:131], v[148:163]
    ds_read_b128 v[124:127], v47 offset:43008
    s_waitcnt lgkmcnt(3)
    v_fma_f32 v168, v168, v70, v70
    v_fma_f32 v169, v169, v70, v70
    v_fma_f32 v170, v170, v70, v70
    v_fma_f32 v171, v171, v70, v70
    v_rcp_f32 v164, v168
    v_mfma_f32_32x32x16_bf16 v[148:163], a[24:27], v[108:111], v[148:163]
    s_add_u32 m0, s69, 0x1000
    s_add_u32 s65, s68, 133120
    buffer_load_dwordx4 v45, s[12:15], s65 offen sc1 lds
    ds_read_b128 v[128:131], v47 offset:44032
    v_rcp_f32 v165, v169
    v_rcp_f32 v166, v170
    v_mfma_f32_32x32x16_bf16 v[148:163], a[28:31], v[112:115], v[148:163]
    ds_read_b128 v[108:111], v47 offset:45056
    s_waitcnt lgkmcnt(3)
    v_rcp_f32 v167, v171
    v_mul_f32 v132, v132, v164
    v_mul_f32 v133, v133, v165
    s_add_u32 m0, s69, 0x1400
    s_add_u32 s65, s68, 166400
    buffer_load_dwordx4 v45, s[12:15], s65 offen sc1 lds
    v_mul_f32 v134, v134, v166
    v_mfma_f32_32x32x16_bf16 v[148:163], a[32:35], v[116:119], v[148:163]
    ds_read_b128 v[112:115], v47 offset:46080
    v_mul_f32 v135, v135, v167
    v_cvt_pk_bf16_f32 v172, v132, v133
    v_cvt_pk_bf16_f32 v173, v134, v135
    v_mul_f32 v164, v136, v136
    v_mul_f32 v165, v137, v137
    v_mfma_f32_32x32x16_bf16 v[148:163], a[36:39], v[120:123], v[148:163]
    ds_read_b128 v[116:119], v47 offset:47104
    s_waitcnt lgkmcnt(3)
    s_add_u32 m0, s69, 0x1800
    s_add_u32 s65, s68, 199680
    buffer_load_dwordx4 v45, s[12:15], s65 offen sc1 lds
    v_mul_f32 v166, v138, v138
    v_mul_f32 v167, v139, v139
    v_fma_f32 v164, v164, v69, v68
    v_fma_f32 v165, v165, v69, v68
    v_fma_f32 v166, v166, v69, v68
    v_mfma_f32_32x32x16_bf16 v[148:163], a[40:43], v[124:127], v[148:163]
    ds_read_b128 v[120:123], v47 offset:48128
    v_fma_f32 v167, v167, v69, v68
    v_mul_f32 v164, v164, v136
    v_mul_f32 v165, v165, v137
    v_mul_f32 v166, v166, v138
    v_mul_f32 v167, v167, v139
    s_add_u32 m0, s69, 0x1c00
    s_add_u32 s65, s68, 232960
    buffer_load_dwordx4 v45, s[12:15], s65 offen sc1 lds
    v_mfma_f32_32x32x16_bf16 v[148:163], a[44:47], v[128:131], v[148:163]
    ds_read_b128 v[124:127], v47 offset:49152
    s_waitcnt lgkmcnt(3)
    v_exp_f32 v168, v164
    v_exp_f32 v169, v165
    v_exp_f32 v170, v166
    v_mfma_f32_32x32x16_bf16 v[148:163], a[48:51], v[108:111], v[148:163]
    ds_read_b128 v[128:131], v47 offset:50176
    s_add_u32 m0, s69, 0x2000
    s_add_u32 s65, s68, 266240
    buffer_load_dwordx4 v45, s[12:15], s65 offen sc1 lds
    v_exp_f32 v171, v167
    v_fma_f32 v168, v168, v70, v70
    v_fma_f32 v169, v169, v70, v70
    v_mfma_f32_32x32x16_bf16 v[148:163], a[52:55], v[112:115], v[148:163]
    ds_read_b128 v[108:111], v47 offset:51200
    s_waitcnt lgkmcnt(3)
    v_fma_f32 v170, v170, v70, v70
    v_fma_f32 v171, v171, v70, v70
    v_rcp_f32 v164, v168
    v_rcp_f32 v165, v169
    s_add_u32 m0, s69, 0x2400
    s_add_u32 s65, s68, 299520
    buffer_load_dwordx4 v45, s[12:15], s65 offen sc1 lds
    v_mfma_f32_32x32x16_bf16 v[148:163], a[56:59], v[116:119], v[148:163]
    ds_read_b128 v[112:115], v47 offset:52224
    v_rcp_f32 v166, v170
    v_rcp_f32 v167, v171
    v_mfma_f32_32x32x16_bf16 v[148:163], a[60:63], v[120:123], v[148:163]
    ds_read_b128 v[116:119], v47 offset:53248
    s_waitcnt lgkmcnt(3)
    v_mul_f32 v136, v136, v164
    s_add_u32 m0, s69, 0x2800
    s_add_u32 s65, s68, 332800
    buffer_load_dwordx4 v45, s[12:15], s65 offen sc1 lds
    v_mul_f32 v137, v137, v165
    v_mul_f32 v138, v138, v166
    v_mul_f32 v139, v139, v167
    v_cvt_pk_bf16_f32 v174, v136, v137
    v_mfma_f32_32x32x16_bf16 v[148:163], a[64:67], v[124:127], v[148:163]
    ds_read_b128 v[120:123], v47 offset:54272
    v_cvt_pk_bf16_f32 v175, v138, v139
    v_mul_f32 v164, v140, v140
    v_mul_f32 v165, v141, v141
    v_mul_f32 v166, v142, v142
    v_mul_f32 v167, v143, v143
    v_mfma_f32_32x32x16_bf16 v[148:163], a[68:71], v[128:131], v[148:163]
    s_add_u32 m0, s69, 0x2c00
    s_add_u32 s65, s68, 366080
    buffer_load_dwordx4 v45, s[12:15], s65 offen sc1 lds
    ds_read_b128 v[124:127], v47 offset:55296
    s_waitcnt lgkmcnt(3)
    v_fma_f32 v164, v164, v69, v68
    v_fma_f32 v165, v165, v69, v68
    v_fma_f32 v166, v166, v69, v68
    v_fma_f32 v167, v167, v69, v68
    v_mul_f32 v164, v164, v140
    v_mfma_f32_32x32x16_bf16 v[148:163], a[72:75], v[108:111], v[148:163]
    ds_read_b128 v[128:131], v47 offset:56320
    v_mul_f32 v165, v165, v141
    v_mul_f32 v166, v166, v142
    v_mul_f32 v167, v167, v143
    s_add_u32 m0, s69, 0x3000
    s_add_u32 s65, s68, 399360
    buffer_load_dwordx4 v45, s[12:15], s65 offen sc1 lds
    v_exp_f32 v168, v164
    v_mfma_f32_32x32x16_bf16 v[148:163], a[76:79], v[112:115], v[148:163]
    ds_read_b128 v[108:111], v47 offset:57344
    s_waitcnt lgkmcnt(3)
    v_exp_f32 v169, v165
    v_exp_f32 v170, v166
    v_exp_f32 v171, v167
    v_mfma_f32_32x32x16_bf16 v[148:163], a[80:83], v[116:119], v[148:163]
    s_add_u32 m0, s69, 0x3400
    s_add_u32 s65, s68, 432640
    buffer_load_dwordx4 v45, s[12:15], s65 offen sc1 lds
    ds_read_b128 v[112:115], v47 offset:58368
    v_fma_f32 v168, v168, v70, v70
    v_fma_f32 v169, v169, v70, v70
    v_fma_f32 v170, v170, v70, v70
    v_fma_f32 v171, v171, v70, v70
    v_mfma_f32_32x32x16_bf16 v[148:163], a[84:87], v[120:123], v[148:163]
    ds_read_b128 v[116:119], v47 offset:59392
    s_waitcnt lgkmcnt(3)
    v_rcp_f32 v164, v168
    v_rcp_f32 v165, v169
    s_add_u32 m0, s69, 0x3800
    s_add_u32 s65, s68, 465920
    buffer_load_dwordx4 v45, s[12:15], s65 offen sc1 lds
    v_rcp_f32 v166, v170
    v_mfma_f32_32x32x16_bf16 v[148:163], a[88:91], v[124:127], v[148:163]
    ds_read_b128 v[120:123], v47 offset:60416
    v_rcp_f32 v167, v171
    v_mul_f32 v140, v140, v164
    v_mul_f32 v141, v141, v165
    v_mfma_f32_32x32x16_bf16 v[148:163], a[92:95], v[128:131], v[148:163]
    ds_read_b128 v[124:127], v47 offset:61440
    s_add_u32 m0, s69, 0x3c00
    s_add_u32 s65, s68, 499200
    buffer_load_dwordx4 v45, s[12:15], s65 offen sc1 lds
    s_waitcnt lgkmcnt(3)
    v_mul_f32 v142, v142, v166
    v_mul_f32 v143, v143, v167
    v_cvt_pk_bf16_f32 v176, v140, v141
    v_cvt_pk_bf16_f32 v177, v142, v143
    v_mul_f32 v164, v144, v144
    v_mfma_f32_32x32x16_bf16 v[148:163], a[96:99], v[108:111], v[148:163]
    ds_read_b128 v[128:131], v47 offset:62464
    v_mul_f32 v165, v145, v145
    v_mul_f32 v166, v146, v146
    v_mul_f32 v167, v147, v147
    v_fma_f32 v164, v164, v69, v68
    v_fma_f32 v165, v165, v69, v68
    v_mfma_f32_32x32x16_bf16 v[148:163], a[100:103], v[112:115], v[148:163]
    ds_read_b128 v[108:111], v47 offset:63488
    s_waitcnt lgkmcnt(3)
    v_fma_f32 v166, v166, v69, v68
    v_fma_f32 v167, v167, v69, v68
    v_mul_f32 v164, v164, v144
    v_mul_f32 v165, v165, v145
    v_mul_f32 v166, v166, v146
    v_mfma_f32_32x32x16_bf16 v[148:163], a[104:107], v[116:119], v[148:163]
    ds_read_b128 v[112:115], v47 offset:64512
    v_mul_f32 v167, v167, v147
    v_exp_f32 v168, v164
    v_exp_f32 v169, v165
    v_mfma_f32_32x32x16_bf16 v[148:163], a[108:111], v[120:123], v[148:163]
    s_waitcnt lgkmcnt(2)
    v_exp_f32 v170, v166
    v_exp_f32 v171, v167
    v_fma_f32 v168, v168, v70, v70
    v_mfma_f32_32x32x16_bf16 v[148:163], a[112:115], v[124:127], v[148:163]
    v_fma_f32 v169, v169, v70, v70
    v_fma_f32 v170, v170, v70, v70
    v_fma_f32 v171, v171, v70, v70
    v_rcp_f32 v164, v168
    v_mfma_f32_32x32x16_bf16 v[148:163], a[116:119], v[128:131], v[148:163]
    s_waitcnt lgkmcnt(0)
    v_rcp_f32 v165, v169
    v_rcp_f32 v166, v170
    v_rcp_f32 v167, v171
    v_mfma_f32_32x32x16_bf16 v[148:163], a[120:123], v[108:111], v[148:163]
    v_mul_f32 v144, v144, v164
    v_mul_f32 v145, v145, v165
    v_mul_f32 v146, v146, v166
    v_mul_f32 v147, v147, v167
    v_mfma_f32_32x32x16_bf16 v[148:163], a[124:127], v[112:115], v[148:163]
    v_cvt_pk_bf16_f32 v178, v144, v145
    v_cvt_pk_bf16_f32 v179, v146, v147
    buffer_store_dwordx4 v[172:175], v30, s[12:15], s44 offen sc1
    buffer_store_dwordx4 v[176:179], v30, s[12:15], s44 offen offset:1024 sc1
    s_add_u32 s44, s44, 114688
    v_mfma_f32_32x32x16_bf16 v[148:163], v[52:55], v[102:105], v[148:163]
    s_nop 11
    v_pk_mul_f32 v[108:109], v[148:149], v[148:149]
    v_pk_mul_f32 v[110:111], v[150:151], v[150:151]
    v_pk_mul_f32 v[112:113], v[152:153], v[152:153]
    v_pk_mul_f32 v[114:115], v[154:155], v[154:155]
    v_pk_fma_f32 v[108:109], v[108:109], v[72:73], v[72:73] op_sel:[0,1,0] op_sel_hi:[1,1,0]
    v_pk_fma_f32 v[110:111], v[110:111], v[72:73], v[72:73] op_sel:[0,1,0] op_sel_hi:[1,1,0]
    v_pk_fma_f32 v[112:113], v[112:113], v[72:73], v[72:73] op_sel:[0,1,0] op_sel_hi:[1,1,0]
    v_pk_fma_f32 v[114:115], v[114:115], v[72:73], v[72:73] op_sel:[0,1,0] op_sel_hi:[1,1,0]
    v_pk_mul_f32 v[108:109], v[108:109], v[148:149]
    v_pk_mul_f32 v[110:111], v[110:111], v[150:151]
    v_pk_mul_f32 v[112:113], v[112:113], v[152:153]
    v_pk_mul_f32 v[114:115], v[114:115], v[154:155]
    v_exp_f32 v116, v108
    v_exp_f32 v117, v109
    v_exp_f32 v118, v110
    v_exp_f32 v119, v111
    v_exp_f32 v120, v112
    v_exp_f32 v121, v113
    v_exp_f32 v122, v114
    v_exp_f32 v123, v115
    v_pk_fma_f32 v[116:117], v[116:117], v[74:75], v[74:75] op_sel_hi:[1,0,0]
    v_pk_fma_f32 v[118:119], v[118:119], v[74:75], v[74:75] op_sel_hi:[1,0,0]
    v_pk_fma_f32 v[120:121], v[120:121], v[74:75], v[74:75] op_sel_hi:[1,0,0]
    v_pk_fma_f32 v[122:123], v[122:123], v[74:75], v[74:75] op_sel_hi:[1,0,0]
    v_rcp_f32 v108, v116
    v_rcp_f32 v109, v117
    v_rcp_f32 v110, v118
    v_rcp_f32 v111, v119
    v_rcp_f32 v112, v120
    v_rcp_f32 v113, v121
    v_rcp_f32 v114, v122
    v_rcp_f32 v115, v123
    v_pk_mul_f32 v[148:149], v[148:149], v[108:109]
    v_pk_mul_f32 v[150:151], v[150:151], v[110:111]
    v_pk_mul_f32 v[152:153], v[152:153], v[112:113]
    v_pk_mul_f32 v[154:155], v[154:155], v[114:115]
    v_cvt_pk_bf16_f32 v172, v148, v149
    v_cvt_pk_bf16_f32 v173, v150, v151
    v_cvt_pk_bf16_f32 v174, v152, v153
    v_cvt_pk_bf16_f32 v175, v154, v155
    v_pk_mul_f32 v[108:109], v[156:157], v[156:157]
    v_pk_mul_f32 v[110:111], v[158:159], v[158:159]
    v_pk_mul_f32 v[112:113], v[160:161], v[160:161]
    v_pk_mul_f32 v[114:115], v[162:163], v[162:163]
    v_pk_fma_f32 v[108:109], v[108:109], v[72:73], v[72:73] op_sel:[0,1,0] op_sel_hi:[1,1,0]
    v_pk_fma_f32 v[110:111], v[110:111], v[72:73], v[72:73] op_sel:[0,1,0] op_sel_hi:[1,1,0]
    v_pk_fma_f32 v[112:113], v[112:113], v[72:73], v[72:73] op_sel:[0,1,0] op_sel_hi:[1,1,0]
    v_pk_fma_f32 v[114:115], v[114:115], v[72:73], v[72:73] op_sel:[0,1,0] op_sel_hi:[1,1,0]
    v_pk_mul_f32 v[108:109], v[108:109], v[156:157]
    v_pk_mul_f32 v[110:111], v[110:111], v[158:159]
    v_pk_mul_f32 v[112:113], v[112:113], v[160:161]
    v_pk_mul_f32 v[114:115], v[114:115], v[162:163]
    v_exp_f32 v116, v108
    v_exp_f32 v117, v109
    v_exp_f32 v118, v110
    v_exp_f32 v119, v111
    v_exp_f32 v120, v112
    v_exp_f32 v121, v113
    v_exp_f32 v122, v114
    v_exp_f32 v123, v115
    v_pk_fma_f32 v[116:117], v[116:117], v[74:75], v[74:75] op_sel_hi:[1,0,0]
    v_pk_fma_f32 v[118:119], v[118:119], v[74:75], v[74:75] op_sel_hi:[1,0,0]
    v_pk_fma_f32 v[120:121], v[120:121], v[74:75], v[74:75] op_sel_hi:[1,0,0]
    v_pk_fma_f32 v[122:123], v[122:123], v[74:75], v[74:75] op_sel_hi:[1,0,0]
    v_rcp_f32 v108, v116
    v_rcp_f32 v109, v117
    v_rcp_f32 v110, v118
    v_rcp_f32 v111, v119
    v_rcp_f32 v112, v120
    v_rcp_f32 v113, v121
    v_rcp_f32 v114, v122
    v_rcp_f32 v115, v123
    v_pk_mul_f32 v[156:157], v[156:157], v[108:109]
    v_pk_mul_f32 v[158:159], v[158:159], v[110:111]
    v_pk_mul_f32 v[160:161], v[160:161], v[112:113]
    v_pk_mul_f32 v[162:163], v[162:163], v[114:115]
    v_cvt_pk_bf16_f32 v176, v156, v157
    v_cvt_pk_bf16_f32 v177, v158, v159
    v_cvt_pk_bf16_f32 v178, v160, v161
    v_cvt_pk_bf16_f32 v179, v162, v163
    buffer_store_dwordx4 v[172:175], v30, s[12:15], s44 offen sc1
    buffer_store_dwordx4 v[176:179], v30, s[12:15], s44 offen offset:1024 sc1
    s_add_u32 s44, s44, 114688
    s_lshl_b32 s56, s63, 2
    s_add_u32 s56, s56, s48
    s_mul_i32 s56, s56, 37
    s_lshr_b32 s56, s56, 9
    s_lshl_b32 s71, s56, 7
    s_lshl_b32 s59, s62, 9
    s_add_u32 s71, s71, s59
    s_add_u32 s71, s71, 0x1306000
    s_branch L_p3done
L_nop3_16:
    s_waitcnt vmcnt(5)
    s_atomic_add s80, s[12:13], s71
    s_waitcnt vmcnt(0)
    v_cmp_gt_u32 s[26:27], 7, v41
    s_cmp_eq_u64 s[26:27], 0
    s_cbranch_scc1 L_pvd_24
    s_mov_b32 s61, 30000
L_pv_23:
    s_sleep 2
    buffer_load_dword v41, v43, s[12:15], s35 offen sc1
    s_waitcnt vmcnt(0)
    v_cmp_gt_u32 s[26:27], 7, v41
    s_cmp_eq_u64 s[26:27], 0
    s_cbranch_scc1 L_pvd_24
    s_sub_u32 s61, s61, 1
    s_cmp_lg_u32 s61, 0
    s_cbranch_scc1 L_pv_23
    s_or_b32 s47, s47, 32
L_pvd_24:
    s_lshl_b32 s24, s50, 6
    s_lshl1_add_u32 s66, s4, 0
    buffer_load_dwordx4 a[128:131], v28, s[12:15], s66 offen sc1
    s_lshl_b32 s25, s54, 5
    s_add_u32 s24, s24, s25
    v_add_u32 v217, s24, v35
    v_xor_b32 v218, 32, v217
    buffer_load_dwordx4 a[132:135], v29, s[12:15], s66 offen sc1
    s_lshl_b32 s24, s48, 6
    v_lshl_add_u32 v219, v36, 2, s24
    v_cmp_eq_u32 s[24:25], 0, v219
    v_cvt_f32_u32 v219, v219
    v_cvt_f32_u32 v200, v217
    buffer_load_dwordx4 a[136:139], v28, s[12:15], s66 offen offset:2048 sc1
    v_mul_f32 v220, 0.5, v200
    v_mul_f32 v200, 0x3b000000, v200
    v_mul_f32 v202, v200, v219
    v_cndmask_b32 v204, v202, v220, s[24:25]
    v_cvt_f32_u32 v201, v218
    buffer_load_dwordx4 a[140:143], v29, s[12:15], s66 offen offset:2048 sc1
    v_mul_f32 v220, 0.5, v201
    v_mul_f32 v201, 0x3b000000, v201
    v_mul_f32 v203, v201, v219
    v_cndmask_b32 v205, v203, v220, s[24:25]
    v_fmamk_f32 v208, v200, 0x00000000, v202
    s_lshl1_add_u32 s66, s4, 4096
    buffer_load_dwordx4 a[144:147], v28, s[12:15], s66 offen sc1
    v_fmamk_f32 v209, v200, 0x3f800000, v202
    v_fmamk_f32 v210, v200, 0x40000000, v202
    v_fmamk_f32 v211, v200, 0x40400000, v202
    v_cos_f32 v224, v208
    buffer_load_dwordx4 a[148:151], v29, s[12:15], s66 offen sc1
    v_sin_f32 v225, v208
    v_cos_f32 v226, v209
    v_sin_f32 v227, v209
    buffer_load_dwordx4 a[152:155], v28, s[12:15], s66 offen offset:2048 sc1
    v_cos_f32 v228, v210
    v_sin_f32 v229, v210
    v_cos_f32 v230, v211
    buffer_load_dwordx4 a[156:159], v29, s[12:15], s66 offen offset:2048 sc1
    v_sin_f32 v231, v211
    v_cos_f32 v204, v204
    v_cvt_pk_bf16_f32 v211, v230, -v231
    s_lshl1_add_u32 s66, s5, 0
    buffer_load_dwordx4 a[160:163], v28, s[12:15], s66 offen sc1
    v_cvt_pk_bf16_f32 v210, v228, -v229
    v_cvt_pk_bf16_f32 v209, v226, -v227
    v_cvt_pk_bf16_f32 v208, v204, -v225
    v_fmamk_f32 v212, v201, 0x00000000, v203
    buffer_load_dwordx4 a[164:167], v29, s[12:15], s66 offen sc1
    v_fmamk_f32 v213, v201, 0x3f800000, v203
    v_fmamk_f32 v214, v201, 0x40000000, v203
    v_fmamk_f32 v215, v201, 0x40400000, v203
    v_cos_f32 v232, v212
    buffer_load_dwordx4 a[168:171], v28, s[12:15], s66 offen offset:2048 sc1
    v_sin_f32 v233, v212
    v_cos_f32 v234, v213
    v_sin_f32 v235, v213
    buffer_load_dwordx4 a[172:175], v29, s[12:15], s66 offen offset:2048 sc1
    v_cos_f32 v236, v214
    v_sin_f32 v237, v214
    v_cos_f32 v238, v215
    s_lshl1_add_u32 s66, s5, 4096
    buffer_load_dwordx4 a[176:179], v28, s[12:15], s66 offen sc1
    v_sin_f32 v239, v215
    v_cos_f32 v205, v205
    buffer_load_dwordx4 a[180:183], v29, s[12:15], s66 offen sc1
    v_cvt_pk_bf16_f32 v215, v238, -v239
    v_cvt_pk_bf16_f32 v214, v236, -v237
    v_cvt_pk_bf16_f32 v213, v234, -v235
    v_cvt_pk_bf16_f32 v212, v205, -v233
    v_fmamk_f32 v216, v200, 0x41000000, v202
    buffer_load_dwordx4 a[184:187], v28, s[12:15], s66 offen offset:2048 sc1
    v_fmamk_f32 v217, v200, 0x41100000, v202
    v_fmamk_f32 v218, v200, 0x41200000, v202
    v_fmamk_f32 v219, v200, 0x41300000, v202
    v_cos_f32 v240, v216
    buffer_load_dwordx4 a[188:191], v29, s[12:15], s66 offen offset:2048 sc1
    v_sin_f32 v241, v216
    v_cos_f32 v242, v217
    v_sin_f32 v243, v217
    s_lshl1_add_u32 s66, s6, 0
    buffer_load_dwordx4 a[192:195], v28, s[12:15], s66 offen sc1
    v_cos_f32 v244, v218
    v_sin_f32 v245, v218
    buffer_load_dwordx4 a[196:199], v29, s[12:15], s66 offen sc1
    v_cos_f32 v246, v219
    v_sin_f32 v247, v219
    s_nop 0
    v_cvt_pk_bf16_f32 v219, v246, -v247
    buffer_load_dwordx4 a[200:203], v28, s[12:15], s66 offen offset:2048 sc1
    v_cvt_pk_bf16_f32 v218, v244, -v245
    v_cvt_pk_bf16_f32 v217, v242, -v243
    v_cvt_pk_bf16_f32 v216, v240, -v241
    v_fmamk_f32 v220, v201, 0x41000000, v203
    v_fmamk_f32 v221, v201, 0x41100000, v203
    buffer_load_dwordx4 a[204:207], v29, s[12:15], s66 offen offset:2048 sc1
    v_fmamk_f32 v222, v201, 0x41200000, v203
    v_fmamk_f32 v223, v201, 0x41300000, v203
    v_cos_f32 v248, v220
    v_sin_f32 v249, v220
    s_lshl1_add_u32 s66, s6, 4096
    buffer_load_dwordx4 a[208:211], v28, s[12:15], s66 offen sc1
    v_cos_f32 v250, v221
    v_sin_f32 v251, v221
    buffer_load_dwordx4 a[212:215], v29, s[12:15], s66 offen sc1
    v_cos_f32 v252, v222
    v_sin_f32 v253, v222
    v_cos_f32 v254, v223
    buffer_load_dwordx4 a[216:219], v28, s[12:15], s66 offen offset:2048 sc1
    v_sin_f32 v255, v223
    s_nop 0
    v_cvt_pk_bf16_f32 v223, v254, -v255
    v_cvt_pk_bf16_f32 v222, v252, -v253
    v_cvt_pk_bf16_f32 v221, v250, -v251
    buffer_load_dwordx4 a[220:223], v29, s[12:15], s66 offen offset:2048 sc1
    v_cvt_pk_bf16_f32 v220, v248, -v249
    v_mul_f32 v200, 0x41000000, v200
    v_cos_f32 v200, v200
    v_mul_f32 v201, 0x41000000, v201
    s_lshl1_add_u32 s66, s7, 0
    buffer_load_dwordx4 a[224:227], v28, s[12:15], s66 offen sc1
    v_cos_f32 v201, v201
    v_add_f32 v200, v200, v200
    v_add_f32 v201, v201, v201
    buffer_load_dwordx4 a[228:231], v29, s[12:15], s66 offen sc1
    buffer_load_dwordx4 a[232:235], v28, s[12:15], s66 offen offset:2048 sc1
    buffer_load_dwordx4 a[236:239], v29, s[12:15], s66 offen offset:2048 sc1
    s_lshl1_add_u32 s66, s7, 4096
    buffer_load_dwordx4 a[240:243], v28, s[12:15], s66 offen sc1
    buffer_load_dwordx4 a[244:247], v29, s[12:15], s66 offen sc1
    buffer_load_dwordx4 a[248:251], v28, s[12:15], s66 offen offset:2048 sc1
    buffer_load_dwordx4 a[252:255], v29, s[12:15], s66 offen offset:2048 sc1
    buffer_load_dword v33, v44, s[12:15], s46 offen sc1
    s_waitcnt vmcnt(0)
    v_cmp_gt_u32 s[26:27], 8, v33
    s_cmp_eq_u64 s[26:27], 0
    s_cbranch_scc1 L_pvd_26
    s_mov_b32 s61, 30000
L_pv_25:
    s_sleep 16
    buffer_load_dword v33, v44, s[12:15], s46 offen sc1
    s_waitcnt vmcnt(0)
    v_cmp_gt_u32 s[26:27], 8, v33
    s_cmp_eq_u64 s[26:27], 0
    s_cbranch_scc1 L_pvd_26
    s_sub_u32 s61, s61, 1
    s_cmp_lg_u32 s61, 0
    s_cbranch_scc1 L_pv_25
    s_or_b32 s47, s47, 128
L_pvd_26:
    s_barrier
    s_add_u32 m0, s69, 0x0
    s_add_u32 s65, s68, 0
    buffer_load_dwordx4 v45, s[12:15], s65 offen sc1 lds
    s_add_u32 m0, s69, 0x400
    s_add_u32 s65, s68, 33280
    buffer_load_dwordx4 v45, s[12:15], s65 offen sc1 lds
    s_add_u32 m0, s69, 0x800
    s_add_u32 s65, s68, 66560
    buffer_load_dwordx4 v45, s[12:15], s65 offen sc1 lds
    s_add_u32 m0, s69, 0xc00
    s_add_u32 s65, s68, 99840
    buffer_load_dwordx4 v45, s[12:15], s65 offen sc1 lds
    s_add_u32 m0, s69, 0x1000
    s_add_u32 s65, s68, 133120
    buffer_load_dwordx4 v45, s[12:15], s65 offen sc1 lds
    s_add_u32 m0, s69, 0x1400
    s_add_u32 s65, s68, 166400
    buffer_load_dwordx4 v45, s[12:15], s65 offen sc1 lds
    s_add_u32 m0, s69, 0x1800
    s_add_u32 s65, s68, 199680
    buffer_load_dwordx4 v45, s[12:15], s65 offen sc1 lds
    s_add_u32 m0, s69, 0x1c00
    s_add_u32 s65, s68, 232960
    buffer_load_dwordx4 v45, s[12:15], s65 offen sc1 lds
    s_add_u32 m0, s69, 0x2000
    s_add_u32 s65, s68, 266240
    buffer_load_dwordx4 v45, s[12:15], s65 offen sc1 lds
    s_add_u32 m0, s69, 0x2400
    s_add_u32 s65, s68, 299520
    buffer_load_dwordx4 v45, s[12:15], s65 offen sc1 lds
    s_add_u32 m0, s69, 0x2800
    s_add_u32 s65, s68, 332800
    buffer_load_dwordx4 v45, s[12:15], s65 offen sc1 lds
    s_add_u32 m0, s69, 0x2c00
    s_add_u32 s65, s68, 366080
    buffer_load_dwordx4 v45, s[12:15], s65 offen sc1 lds
    s_add_u32 m0, s69, 0x3000
    s_add_u32 s65, s68, 399360
    buffer_load_dwordx4 v45, s[12:15], s65 offen sc1 lds
    s_add_u32 m0, s69, 0x3400
    s_add_u32 s65, s68, 432640
    buffer_load_dwordx4 v45, s[12:15], s65 offen sc1 lds
    s_add_u32 m0, s69, 0x3800
    s_add_u32 s65, s68, 465920
    buffer_load_dwordx4 v45, s[12:15], s65 offen sc1 lds
    s_add_u32 m0, s69, 0x3c00
    s_add_u32 s65, s68, 499200
    buffer_load_dwordx4 v45, s[12:15], s65 offen sc1 lds
    s_waitcnt vmcnt(0)
    s_mov_b32 s71, 0x7f000000
L_p3done:
    s_lshl_b32 s56, s55, 6
    v_lshl_or_b32 v5, v36, 10, v31
    v_add_u32 v5, s69, v5
    v_xor_b32 v47, s56, v5
    v_xor_b32 v46, 64, v47
    s_barrier
    s_waitcnt vmcnt(18)
    ds_read_b64_tr_b16 v[80:81], v46 offset:0
    ds_read_b64_tr_b16 v[82:83], v46 offset:512
    ds_read_b64_tr_b16 v[84:85], v47 offset:0
    ds_read_b64_tr_b16 v[86:87], v47 offset:512
    s_waitcnt vmcnt(16)
    ds_read_b64_tr_b16 v[88:89], v46 offset:2048
    ds_read_b64_tr_b16 v[90:91], v46 offset:2560
    ds_read_b64_tr_b16 v[92:93], v47 offset:2048
    ds_read_b64_tr_b16 v[94:95], v47 offset:2560
    s_waitcnt lgkmcnt(6)
    s_xor_b32 s56, s48, 2
    s_lshl_b32 s57, s56, 14
    s_lshl_b32 s59, s48, 12
    s_lshl1_add_u32 s66, s8, 0
    buffer_load_dwordx4 a[0:3], v28, s[12:15], s66 offen sc1
    s_add_u32 s57, s57, s59
    s_add_u32 s57, s57, 0x10000
    v_add_u32 v104, s57, v30
    s_lshl_b32 s57, s48, 14
    s_lshl_b32 s59, s56, 12
    s_add_u32 s57, s57, s59
    s_add_u32 s57, s57, 0x10000
    v_mfma_f32_32x32x16_bf16 v[128:143], v[208:211], v[80:83], 0
    buffer_load_dwordx4 a[4:7], v29, s[12:15], s66 offen sc1
    v_add_u32 v107, s57, v30
    s_xor_b32 s56, s48, 3
    s_lshl_b32 s57, s56, 14
    s_lshl_b32 s59, s48, 12
    s_add_u32 s57, s57, s59
    s_add_u32 s57, s57, 0x10000
    v_add_u32 v105, s57, v30
    s_lshl_b32 s57, s48, 14
    s_lshl_b32 s59, s56, 12
    buffer_load_dwordx4 a[8:11], v28, s[12:15], s66 offen offset:2048 sc1
    v_mfma_f32_32x32x16_bf16 v[144:159], v[212:215], v[80:83], 0
    s_waitcnt vmcnt(17)
    ds_read_b64_tr_b16 v[96:97], v46 offset:4096
    ds_read_b64_tr_b16 v[98:99], v46 offset:4608
    ds_read_b64_tr_b16 v[100:101], v47 offset:4096
    ds_read_b64_tr_b16 v[102:103], v47 offset:4608
    s_waitcnt lgkmcnt(8)
    s_add_u32 s57, s57, s59
    buffer_load_dwordx4 a[12:15], v29, s[12:15], s66 offen offset:2048 sc1
    s_add_u32 s57, s57, 0x10000
    v_add_u32 v108, s57, v30
    s_xor_b32 s56, s48, 1
    s_lshl_b32 s57, s56, 14
    s_lshl_b32 s59, s48, 12
    s_add_u32 s57, s57, s59
    s_add_u32 s57, s57, 0x10000
    v_add_u32 v106, s57, v30
    s_lshl_b32 s57, s48, 14
    s_lshl1_add_u32 s66, s8, 4096
    buffer_load_dwordx4 a[16:19], v28, s[12:15], s66 offen sc1
    v_mfma_f32_32x32x16_bf16 v[48:63], v[208:211], v[84:87], 0
    s_lshl_b32 s59, s56, 12
    s_add_u32 s57, s57, s59
    s_add_u32 s57, s57, 0x10000
    v_add_u32 v109, s57, v30
    s_lshr_b32 s46, s49, 1
    s_lshl_b32 s46, s46, 9
    buffer_load_dwordx4 a[20:23], v29, s[12:15], s66 offen sc1
    s_lshl_b32 s59, s48, 7
    s_add_u32 s46, s46, s59
    s_add_u32 s46, s46, 0x1306000
    v_mfma_f32_32x32x16_bf16 v[176:191], v[212:215], v[84:87], 0
    s_waitcnt lgkmcnt(6)
    v_fma_f32 v224, v240, v200, -v224
    v_fma_f32 v225, v241, v200, -v225
    v_fma_f32 v226, v242, v200, -v226
    buffer_load_dwordx4 a[24:27], v28, s[12:15], s66 offen offset:2048 sc1
    v_fma_f32 v227, v243, v200, -v227
    v_fma_f32 v228, v244, v200, -v228
    v_fma_f32 v229, v245, v200, -v229
    v_mfma_f32_32x32x16_bf16 v[128:143], v[216:219], v[88:91], v[128:143]
    v_fma_f32 v230, v246, v200, -v230
    v_fma_f32 v231, v247, v200, -v231
    v_cvt_pk_bf16_f32 v208, v224, -v225
    v_cvt_pk_bf16_f32 v209, v226, -v227
    buffer_load_dwordx4 a[28:31], v29, s[12:15], s66 offen offset:2048 sc1
    v_cvt_pk_bf16_f32 v210, v228, -v229
    v_cvt_pk_bf16_f32 v211, v230, -v231
    v_mfma_f32_32x32x16_bf16 v[144:159], v[220:223], v[88:91], v[144:159]
    s_waitcnt vmcnt(20)
    ds_read_b64_tr_b16 v[80:81], v46 offset:6144
    ds_read_b64_tr_b16 v[82:83], v46 offset:6656
    ds_read_b64_tr_b16 v[84:85], v47 offset:6144
    ds_read_b64_tr_b16 v[86:87], v47 offset:6656
    s_lshl1_add_u32 s66, s9, 0
    buffer_load_dwordx4 a[32:35], v28, s[12:15], s66 offen sc1
    s_waitcnt lgkmcnt(8)
    v_fma_f32 v232, v248, v201, -v232
    v_fma_f32 v233, v249, v201, -v233
    v_fma_f32 v234, v250, v201, -v234
    v_fma_f32 v235, v251, v201, -v235
    v_fma_f32 v236, v252, v201, -v236
    v_fma_f32 v237, v253, v201, -v237
    v_mfma_f32_32x32x16_bf16 v[48:63], v[216:219], v[92:95], v[48:63]
    buffer_load_dwordx4 a[36:39], v29, s[12:15], s66 offen sc1
    v_fma_f32 v238, v254, v201, -v238
    v_fma_f32 v239, v255, v201, -v239
    v_cvt_pk_bf16_f32 v212, v232, -v233
    v_cvt_pk_bf16_f32 v213, v234, -v235
    v_cvt_pk_bf16_f32 v214, v236, -v237
    v_cvt_pk_bf16_f32 v215, v238, -v239
    v_mfma_f32_32x32x16_bf16 v[176:191], v[220:223], v[92:95], v[176:191]
    s_waitcnt lgkmcnt(6)
    v_fma_f32 v240, v224, v200, -v240
    v_fma_f32 v241, v225, v200, -v241
    v_fma_f32 v242, v226, v200, -v242
    v_fma_f32 v243, v227, v200, -v243
    v_fma_f32 v244, v228, v200, -v244
    v_fma_f32 v245, v229, v200, -v245
    v_mfma_f32_32x32x16_bf16 v[128:143], v[208:211], v[96:99], v[128:143]
    v_fma_f32 v246, v230, v200, -v246
    v_fma_f32 v247, v231, v200, -v247
    v_cvt_pk_bf16_f32 v216, v240, -v241
    v_cvt_pk_bf16_f32 v217, v242, -v243
    v_cvt_pk_bf16_f32 v218, v244, -v245
    v_cvt_pk_bf16_f32 v219, v246, -v247
    v_mfma_f32_32x32x16_bf16 v[144:159], v[212:215], v[96:99], v[144:159]
    s_waitcnt vmcnt(20)
    ds_read_b64_tr_b16 v[88:89], v46 offset:8192
    ds_read_b64_tr_b16 v[90:91], v46 offset:8704
    ds_read_b64_tr_b16 v[92:93], v47 offset:8192
    ds_read_b64_tr_b16 v[94:95], v47 offset:8704
    s_waitcnt lgkmcnt(8)
    v_fma_f32 v248, v232, v201, -v248
    v_fma_f32 v249, v233, v201, -v249
    v_fma_f32 v250, v234, v201, -v250
    v_fma_f32 v251, v235, v201, -v251
    v_fma_f32 v252, v236, v201, -v252
    v_fma_f32 v253, v237, v201, -v253
    v_mfma_f32_32x32x16_bf16 v[48:63], v[208:211], v[100:103], v[48:63]
    v_fma_f32 v254, v238, v201, -v254
    v_fma_f32 v255, v239, v201, -v255
    v_cvt_pk_bf16_f32 v220, v248, -v249
    v_cvt_pk_bf16_f32 v221, v250, -v251
    v_cvt_pk_bf16_f32 v222, v252, -v253
    v_cvt_pk_bf16_f32 v223, v254, -v255
    v_mfma_f32_32x32x16_bf16 v[176:191], v[212:215], v[100:103], v[176:191]
    s_waitcnt lgkmcnt(6)
    v_fma_f32 v224, v240, v200, -v224
    v_fma_f32 v225, v241, v200, -v225
    v_fma_f32 v226, v242, v200, -v226
    v_fma_f32 v227, v243, v200, -v227
    v_fma_f32 v228, v244, v200, -v228
    v_fma_f32 v229, v245, v200, -v229
    v_mfma_f32_32x32x16_bf16 v[128:143], v[216:219], v[80:83], v[128:143]
    v_fma_f32 v230, v246, v200, -v230
    v_fma_f32 v231, v247, v200, -v231
    v_cvt_pk_bf16_f32 v208, v224, -v225
    v_cvt_pk_bf16_f32 v209, v226, -v227
    v_cvt_pk_bf16_f32 v210, v228, -v229
    v_cvt_pk_bf16_f32 v211, v230, -v231
    v_mfma_f32_32x32x16_bf16 v[144:159], v[220:223], v[80:83], v[144:159]
    s_waitcnt vmcnt(18)
    ds_read_b64_tr_b16 v[96:97], v46 offset:10240
    ds_read_b64_tr_b16 v[98:99], v46 offset:10752
    ds_read_b64_tr_b16 v[100:101], v47 offset:10240
    ds_read_b64_tr_b16 v[102:103], v47 offset:10752
    s_waitcnt lgkmcnt(8)
    v_fma_f32 v232, v248, v201, -v232
    v_fma_f32 v233, v249, v201, -v233
    v_fma_f32 v234, v250, v201, -v234
    v_fma_f32 v235, v251, v201, -v235
    v_fma_f32 v236, v252, v201, -v236
    v_fma_f32 v237, v253, v201, -v237
    v_mfma_f32_32x32x16_bf16 v[48:63], v[216:219], v[84:87], v[48:63]
    v_fma_f32 v238, v254, v201, -v238
    v_fma_f32 v239, v255, v201, -v239
    v_cvt_pk_bf16_f32 v212, v232, -v233
    v_cvt_pk_bf16_f32 v213, v234, -v235
    v_cvt_pk_bf16_f32 v214, v236, -v237
    v_cvt_pk_bf16_f32 v215, v238, -v239
    v_mfma_f32_32x32x16_bf16 v[176:191], v[220:223], v[84:87], v[176:191]
    s_waitcnt vmcnt(10)
    s_cmp_eq_u32 s71, 0x7f000000
    s_cbranch_scc1 L_ns_27
    s_atomic_add s80, s[12:13], s71
L_ns_27:
    s_waitcnt lgkmcnt(6)
    v_fma_f32 v240, v224, v200, -v240
    v_fma_f32 v241, v225, v200, -v241
    v_fma_f32 v242, v226, v200, -v242
    buffer_load_dwordx4 a[40:43], v28, s[12:15], s66 offen offset:2048 sc1
    v_fma_f32 v243, v227, v200, -v243
    v_fma_f32 v244, v228, v200, -v244
    v_fma_f32 v245, v229, v200, -v245
    v_mfma_f32_32x32x16_bf16 v[128:143], v[208:211], v[88:91], v[128:143]
    v_fma_f32 v246, v230, v200, -v246
    v_fma_f32 v247, v231, v200, -v247
    v_cvt_pk_bf16_f32 v216, v240, -v241
    v_cvt_pk_bf16_f32 v217, v242, -v243
    v_cvt_pk_bf16_f32 v218, v244, -v245
    v_cvt_pk_bf16_f32 v219, v246, -v247
    v_mfma_f32_32x32x16_bf16 v[144:159], v[212:215], v[88:91], v[144:159]
    ds_read_b64_tr_b16 v[80:81], v46 offset:12288
    buffer_load_dwordx4 a[44:47], v29, s[12:15], s66 offen offset:2048 sc1
    ds_read_b64_tr_b16 v[82:83], v46 offset:12800
    ds_read_b64_tr_b16 v[84:85], v47 offset:12288
    ds_read_b64_tr_b16 v[86:87], v47 offset:12800
    s_waitcnt lgkmcnt(8)
    v_fma_f32 v248, v232, v201, -v248
    v_fma_f32 v249, v233, v201, -v249
    v_fma_f32 v250, v234, v201, -v250
    v_fma_f32 v251, v235, v201, -v251
    v_fma_f32 v252, v236, v201, -v252
    v_fma_f32 v253, v237, v201, -v253
    v_mfma_f32_32x32x16_bf16 v[48:63], v[208:211], v[92:95], v[48:63]
    v_fma_f32 v254, v238, v201, -v254
    v_fma_f32 v255, v239, v201, -v255
    v_cvt_pk_bf16_f32 v220, v248, -v249
    s_lshl1_add_u32 s66, s9, 4096
    buffer_load_dwordx4 a[48:51], v28, s[12:15], s66 offen sc1
    v_cvt_pk_bf16_f32 v221, v250, -v251
    v_cvt_pk_bf16_f32 v222, v252, -v253
    v_cvt_pk_bf16_f32 v223, v254, -v255
    v_mfma_f32_32x32x16_bf16 v[176:191], v[212:215], v[92:95], v[176:191]
    s_waitcnt lgkmcnt(6)
    v_fma_f32 v224, v240, v200, -v224
    v_fma_f32 v225, v241, v200, -v225
    v_fma_f32 v226, v242, v200, -v226
    buffer_load_dwordx4 a[52:55], v29, s[12:15], s66 offen sc1
    v_fma_f32 v227, v243, v200, -v227
    v_fma_f32 v228, v244, v200, -v228
    v_fma_f32 v229, v245, v200, -v229
    v_mfma_f32_32x32x16_bf16 v[128:143], v[216:219], v[96:99], v[128:143]
    v_fma_f32 v230, v246, v200, -v230
    v_fma_f32 v231, v247, v200, -v231
    v_cvt_pk_bf16_f32 v208, v224, -v225
    v_cvt_pk_bf16_f32 v209, v226, -v227
    v_cvt_pk_bf16_f32 v210, v228, -v229
    v_cvt_pk_bf16_f32 v211, v230, -v231
    v_mfma_f32_32x32x16_bf16 v[144:159], v[220:223], v[96:99], v[144:159]
    ds_read_b64_tr_b16 v[88:89], v46 offset:14336
    buffer_load_dwordx4 a[56:59], v28, s[12:15], s66 offen offset:2048 sc1
    ds_read_b64_tr_b16 v[90:91], v46 offset:14848
    ds_read_b64_tr_b16 v[92:93], v47 offset:14336
    ds_read_b64_tr_b16 v[94:95], v47 offset:14848
    s_waitcnt lgkmcnt(8)
    v_fma_f32 v232, v248, v201, -v232
    v_fma_f32 v233, v249, v201, -v233
    v_fma_f32 v234, v250, v201, -v234
    v_fma_f32 v235, v251, v201, -v235
    v_fma_f32 v236, v252, v201, -v236
    v_fma_f32 v237, v253, v201, -v237
    v_mfma_f32_32x32x16_bf16 v[48:63], v[216:219], v[100:103], v[48:63]
    v_fma_f32 v238, v254, v201, -v238
    v_fma_f32 v239, v255, v201, -v239
    v_cvt_pk_bf16_f32 v212, v232, -v233
    buffer_load_dwordx4 a[60:63], v29, s[12:15], s66 offen offset:2048 sc1
    v_cvt_pk_bf16_f32 v213, v234, -v235
    v_cvt_pk_bf16_f32 v214, v236, -v237
    v_cvt_pk_bf16_f32 v215, v238, -v239
    v_mfma_f32_32x32x16_bf16 v[176:191], v[220:223], v[100:103], v[176:191]
    s_waitcnt lgkmcnt(6)
    v_fma_f32 v240, v224, v200, -v240
    v_fma_f32 v241, v225, v200, -v241
    v_fma_f32 v242, v226, v200, -v242
    s_lshl1_add_u32 s66, s10, 0
    buffer_load_dwordx4 a[64:67], v28, s[12:15], s66 offen sc1
    v_fma_f32 v243, v227, v200, -v243
    v_fma_f32 v244, v228, v200, -v244
    v_fma_f32 v245, v229, v200, -v245
    v_mfma_f32_32x32x16_bf16 v[128:143], v[208:211], v[80:83], v[128:143]
    v_fma_f32 v246, v230, v200, -v246
    v_fma_f32 v247, v231, v200, -v247
    v_cvt_pk_bf16_f32 v216, v240, -v241
    v_cvt_pk_bf16_f32 v217, v242, -v243
    v_cvt_pk_bf16_f32 v218, v244, -v245
    v_cvt_pk_bf16_f32 v219, v246, -v247
    v_mfma_f32_32x32x16_bf16 v[144:159], v[212:215], v[80:83], v[144:159]
    s_waitcnt lgkmcnt(4)
    buffer_load_dwordx4 a[68:71], v29, s[12:15], s66 offen sc1
    v_fma_f32 v248, v232, v201, -v248
    v_fma_f32 v249, v233, v201, -v249
    v_fma_f32 v250, v234, v201, -v250
    v_fma_f32 v251, v235, v201, -v251
    v_fma_f32 v252, v236, v201, -v252
    v_fma_f32 v253, v237, v201, -v253
    v_mfma_f32_32x32x16_bf16 v[48:63], v[208:211], v[84:87], v[48:63]
    v_fma_f32 v254, v238, v201, -v254
    v_fma_f32 v255, v239, v201, -v255
    v_cvt_pk_bf16_f32 v220, v248, -v249
    v_cvt_pk_bf16_f32 v221, v250, -v251
    v_cvt_pk_bf16_f32 v222, v252, -v253
    v_cvt_pk_bf16_f32 v223, v254, -v255
    v_mfma_f32_32x32x16_bf16 v[176:191], v[212:215], v[84:87], v[176:191]
    s_load_dword s60, s[12:13], s46 glc
    s_waitcnt lgkmcnt(2)
    s_lshl_b32 s56, s49, 1
    s_add_u32 s56, s56, s55
    s_xor_b32 s57, s56, 1
    buffer_load_dwordx4 a[72:75], v28, s[12:15], s66 offen offset:2048 sc1
    v_mfma_f32_32x32x16_bf16 v[128:143], v[216:219], v[88:91], v[128:143]
    s_mul_i32 s58, s48, 28672
    s_add_u32 s58, s58, 0xb80000
    s_mul_i32 s56, s56, 114688
    v_mfma_f32_32x32x16_bf16 v[144:159], v[220:223], v[88:91], v[144:159]
    s_waitcnt lgkmcnt(0)
    s_mul_i32 s57, s57, 114688
    s_add_u32 s56, s56, s58
    v_mfma_f32_32x32x16_bf16 v[48:63], v[216:219], v[92:95], v[48:63]
    buffer_load_dwordx4 a[76:79], v29, s[12:15], s66 offen offset:2048 sc1
    s_add_u32 s57, s57, s58
    v_add_u32 v110, s57, v30
    v_add_u32 v111, s56, v30
    v_mfma_f32_32x32x16_bf16 v[176:191], v[220:223], v[92:95], v[176:191]
    s_lshl1_add_u32 s66, s10, 4096
    buffer_load_dwordx4 a[80:83], v28, s[12:15], s66 offen sc1
    ds_write_b128 v104, v[128:131] offset:0
    ds_write_b128 v104, v[132:135] offset:1024
    ds_write_b128 v104, v[136:139] offset:2048
    ds_write_b128 v104, v[140:143] offset:3072
    ds_write_b128 v105, v[144:147] offset:0
    ds_write_b128 v105, v[148:151] offset:1024
    ds_write_b128 v105, v[152:155] offset:2048
    ds_write_b128 v105, v[156:159] offset:3072
    buffer_load_dwordx4 a[84:87], v29, s[12:15], s66 offen sc1
    s_nop 0
    ds_write_b128 v106, v[176:179] offset:0
    ds_write_b128 v106, v[180:183] offset:1024
    ds_write_b128 v106, v[184:187] offset:2048
    ds_write_b128 v106, v[188:191] offset:3072
    s_waitcnt lgkmcnt(0)
    s_cmp_ge_u32 s60, 14
    s_cbranch_scc1 L_psd_29
    s_mov_b32 s61, 30000
L_ps_28:
    s_load_dword s60, s[12:13], s46 glc
    s_waitcnt lgkmcnt(0)
    s_cmp_ge_u32 s60, 14
    s_cbranch_scc1 L_psd_29
    s_sub_u32 s61, s61, 1
    s_cmp_lg_u32 s61, 0
    s_cbranch_scc1 L_ps_28
    s_or_b32 s47, s47, 256
L_psd_29:
    buffer_load_dwordx4 v[192:195], v110, s[12:15], s4 offen sc1
    buffer_load_dwordx4 v[196:199], v110, s[12:15], s4 offen offset:1024 sc1
    buffer_load_dwordx4 v[200:203], v110, s[12:15], s4 offen offset:2048 sc1
    buffer_load_dwordx4 v[204:207], v110, s[12:15], s4 offen offset:3072 sc1
    buffer_load_dwordx4 v[208:211], v110, s[12:15], s5 offen sc1
    buffer_load_dwordx4 v[212:215], v110, s[12:15], s5 offen offset:1024 sc1
    buffer_load_dwordx4 v[216:219], v110, s[12:15], s5 offen offset:2048 sc1
    buffer_load_dwordx4 v[220:223], v110, s[12:15], s5 offen offset:3072 sc1
    buffer_load_dwordx4 v[224:227], v110, s[12:15], s6 offen sc1
    buffer_load_dwordx4 v[228:231], v110, s[12:15], s6 offen offset:1024 sc1
    buffer_load_dwordx4 v[232:235], v110, s[12:15], s6 offen offset:2048 sc1
    buffer_load_dwordx4 v[236:239], v110, s[12:15], s6 offen offset:3072 sc1
    buffer_load_dwordx4 v[240:243], v110, s[12:15], s7 offen sc1
    buffer_load_dwordx4 v[244:247], v110, s[12:15], s7 offen offset:1024 sc1
    s_waitcnt vmcnt(13)
    v_mfma_f32_32x32x16_bf16 v[128:143], a[128:131], v[192:195], 0
    v_mfma_f32_32x32x16_bf16 v[144:159], a[132:135], v[192:195], 0
    buffer_load_dwordx4 a[88:91], v28, s[12:15], s66 offen offset:2048 sc1
    buffer_load_dwordx4 v[192:195], v110, s[12:15], s7 offen offset:2048 sc1
    s_waitcnt vmcnt(14)
    v_mfma_f32_32x32x16_bf16 v[128:143], a[136:139], v[196:199], v[128:143]
    v_mfma_f32_32x32x16_bf16 v[144:159], a[140:143], v[196:199], v[144:159]
    buffer_load_dwordx4 a[92:95], v29, s[12:15], s66 offen offset:2048 sc1
    buffer_load_dwordx4 v[196:199], v110, s[12:15], s7 offen offset:3072 sc1
    s_waitcnt vmcnt(15)
    v_mfma_f32_32x32x16_bf16 v[128:143], a[144:147], v[200:203], v[128:143]
    v_mfma_f32_32x32x16_bf16 v[144:159], a[148:151], v[200:203], v[144:159]
    buffer_load_dwordx4 v[200:203], v110, s[12:15], s8 offen sc1
    s_waitcnt vmcnt(15)
    v_mfma_f32_32x32x16_bf16 v[128:143], a[152:155], v[204:207], v[128:143]
    v_mfma_f32_32x32x16_bf16 v[144:159], a[156:159], v[204:207], v[144:159]
    buffer_load_dwordx4 v[204:207], v110, s[12:15], s8 offen offset:1024 sc1
    s_waitcnt vmcnt(15)
    v_mfma_f32_32x32x16_bf16 v[128:143], a[160:163], v[208:211], v[128:143]
    v_mfma_f32_32x32x16_bf16 v[144:159], a[164:167], v[208:211], v[144:159]
    buffer_load_dwordx4 v[208:211], v110, s[12:15], s8 offen offset:2048 sc1
    s_waitcnt vmcnt(15)
    v_mfma_f32_32x32x16_bf16 v[128:143], a[168:171], v[212:215], v[128:143]
    v_mfma_f32_32x32x16_bf16 v[144:159], a[172:175], v[212:215], v[144:159]
    buffer_load_dwordx4 v[212:215], v110, s[12:15], s8 offen offset:3072 sc1
    s_waitcnt vmcnt(15)
    v_mfma_f32_32x32x16_bf16 v[128:143], a[176:179], v[216:219], v[128:143]
    s_barrier
    ds_read_b128 v[64:67], v107 offset:0
    v_mfma_f32_32x32x16_bf16 v[144:159], a[180:183], v[216:219], v[144:159]
    buffer_load_dwordx4 v[216:219], v110, s[12:15], s9 offen sc1
    s_waitcnt vmcnt(15)
    ds_read_b128 v[68:71], v107 offset:1024
    ds_read_b128 v[72:75], v107 offset:2048
    v_mfma_f32_32x32x16_bf16 v[128:143], a[184:187], v[220:223], v[128:143]
    ds_read_b128 v[76:79], v107 offset:3072
    v_add_u32 v104, 0xffff0000, v104
    v_mfma_f32_32x32x16_bf16 v[144:159], a[188:191], v[220:223], v[144:159]
    buffer_load_dwordx4 v[220:223], v110, s[12:15], s9 offen offset:1024 sc1
    s_waitcnt vmcnt(15)
    v_add_u32 v107, 0xffff0000, v107
    v_mfma_f32_32x32x16_bf16 v[128:143], a[192:195], v[224:227], v[128:143]
    s_waitcnt lgkmcnt(3)
    v_add_f32 v48, v48, v64
    v_mfma_f32_32x32x16_bf16 v[144:159], a[196:199], v[224:227], v[144:159]
    buffer_load_dwordx4 v[224:227], v110, s[12:15], s9 offen offset:2048 sc1
    s_waitcnt vmcnt(15)
    v_add_f32 v49, v49, v65
    v_add_f32 v50, v50, v66
    v_mfma_f32_32x32x16_bf16 v[128:143], a[200:203], v[228:231], v[128:143]
    v_add_f32 v51, v51, v67
    s_waitcnt lgkmcnt(2)
    v_mfma_f32_32x32x16_bf16 v[144:159], a[204:207], v[228:231], v[144:159]
    buffer_load_dwordx4 v[228:231], v110, s[12:15], s9 offen offset:3072 sc1
    s_waitcnt vmcnt(15)
    v_add_f32 v52, v52, v68
    v_add_f32 v53, v53, v69
    v_mfma_f32_32x32x16_bf16 v[128:143], a[208:211], v[232:235], v[128:143]
    v_add_f32 v54, v54, v70
    v_add_f32 v55, v55, v71
    v_mfma_f32_32x32x16_bf16 v[144:159], a[212:215], v[232:235], v[144:159]
    buffer_load_dwordx4 v[232:235], v110, s[12:15], s10 offen sc1
    s_waitcnt vmcnt(15)
    s_waitcnt lgkmcnt(1)
    v_mfma_f32_32x32x16_bf16 v[128:143], a[216:219], v[236:239], v[128:143]
    v_add_f32 v56, v56, v72
    v_add_f32 v57, v57, v73
    v_mfma_f32_32x32x16_bf16 v[144:159], a[220:223], v[236:239], v[144:159]
    buffer_load_dwordx4 v[236:239], v110, s[12:15], s10 offen offset:1024 sc1
    s_waitcnt vmcnt(15)
    v_add_f32 v58, v58, v74
    v_add_f32 v59, v59, v75
    v_mfma_f32_32x32x16_bf16 v[128:143], a[224:227], v[240:243], v[128:143]
    s_waitcnt lgkmcnt(0)
    v_add_f32 v60, v60, v76
    v_mfma_f32_32x32x16_bf16 v[144:159], a[228:231], v[240:243], v[144:159]
    buffer_load_dwordx4 v[240:243], v110, s[12:15], s10 offen offset:2048 sc1
    s_waitcnt vmcnt(15)
    v_add_f32 v61, v61, v77
    v_add_f32 v62, v62, v78
    v_mfma_f32_32x32x16_bf16 v[128:143], a[232:235], v[244:247], v[128:143]
    v_add_f32 v63, v63, v79
    ds_read_b128 v[64:67], v108 offset:0
    v_mfma_f32_32x32x16_bf16 v[144:159], a[236:239], v[244:247], v[144:159]
    buffer_load_dwordx4 v[244:247], v110, s[12:15], s10 offen offset:3072 sc1
    s_waitcnt vmcnt(14)
    ds_read_b128 v[68:71], v108 offset:1024
    v_mfma_f32_32x32x16_bf16 v[128:143], a[240:243], v[192:195], v[128:143]
    ds_read_b128 v[72:75], v108 offset:2048
    ds_read_b128 v[76:79], v108 offset:3072
    v_mfma_f32_32x32x16_bf16 v[144:159], a[244:247], v[192:195], v[144:159]
    buffer_load_dwordx4 v[192:195], v111, s[12:15], s4 offen sc1
    s_waitcnt vmcnt(13)
    v_add_u32 v105, 0xffff0000, v105
    v_add_u32 v108, 0xffff0000, v108
    v_mfma_f32_32x32x16_bf16 v[128:143], a[248:251], v[196:199], v[128:143]
    s_waitcnt lgkmcnt(3)
    v_add_f32 v48, v48, v64
    v_mfma_f32_32x32x16_bf16 v[144:159], a[252:255], v[196:199], v[144:159]
    buffer_load_dwordx4 v[196:199], v111, s[12:15], s4 offen offset:1024 sc1
    s_waitcnt vmcnt(13)
    v_add_f32 v49, v49, v65
    v_add_f32 v50, v50, v66
    v_mfma_f32_32x32x16_bf16 v[128:143], a[0:3], v[200:203], v[128:143]
    v_add_f32 v51, v51, v67
    s_waitcnt lgkmcnt(2)
    v_mfma_f32_32x32x16_bf16 v[144:159], a[4:7], v[200:203], v[144:159]
    buffer_load_dwordx4 v[200:203], v111, s[12:15], s4 offen offset:2048 sc1
    s_waitcnt vmcnt(13)
    v_add_f32 v52, v52, v68
    v_mfma_f32_32x32x16_bf16 v[128:143], a[8:11], v[204:207], v[128:143]
    v_add_f32 v53, v53, v69
    v_add_f32 v54, v54, v70
    v_mfma_f32_32x32x16_bf16 v[144:159], a[12:15], v[204:207], v[144:159]
    buffer_load_dwordx4 v[204:207], v111, s[12:15], s4 offen offset:3072 sc1
    s_waitcnt vmcnt(13)
    v_add_f32 v55, v55, v71
    s_waitcnt lgkmcnt(1)
    v_mfma_f32_32x32x16_bf16 v[128:143], a[16:19], v[208:211], v[128:143]
    v_add_f32 v56, v56, v72
    v_add_f32 v57, v57, v73
    v_mfma_f32_32x32x16_bf16 v[144:159], a[20:23], v[208:211], v[144:159]
    buffer_load_dwordx4 v[208:211], v111, s[12:15], s5 offen sc1
    s_waitcnt vmcnt(13)
    v_add_f32 v58, v58, v74
    v_add_f32 v59, v59, v75
    v_mfma_f32_32x32x16_bf16 v[128:143], a[24:27], v[212:215], v[128:143]
    s_waitcnt lgkmcnt(0)
    v_add_f32 v60, v60, v76
    v_mfma_f32_32x32x16_bf16 v[144:159], a[28:31], v[212:215], v[144:159]
    buffer_load_dwordx4 v[212:215], v111, s[12:15], s5 offen offset:1024 sc1
    s_waitcnt vmcnt(13)
    v_add_f32 v61, v61, v77
    v_mfma_f32_32x32x16_bf16 v[128:143], a[32:35], v[216:219], v[128:143]
    v_add_f32 v62, v62, v78
    v_add_f32 v63, v63, v79
    v_mfma_f32_32x32x16_bf16 v[144:159], a[36:39], v[216:219], v[144:159]
    buffer_load_dwordx4 v[216:219], v111, s[12:15], s5 offen offset:2048 sc1
    s_waitcnt vmcnt(13)
    ds_read_b128 v[64:67], v109 offset:0
    ds_read_b128 v[68:71], v109 offset:1024
    v_mfma_f32_32x32x16_bf16 v[128:143], a[40:43], v[220:223], v[128:143]
    ds_read_b128 v[72:75], v109 offset:2048
    ds_read_b128 v[76:79], v109 offset:3072
    v_mfma_f32_32x32x16_bf16 v[144:159], a[44:47], v[220:223], v[144:159]
    buffer_load_dwordx4 v[220:223], v111, s[12:15], s5 offen offset:3072 sc1
    s_waitcnt vmcnt(13)
    v_add_u32 v106, 0xffff0000, v106
    v_add_u32 v109, 0xffff0000, v109
    v_mfma_f32_32x32x16_bf16 v[128:143], a[48:51], v[224:227], v[128:143]
    s_waitcnt lgkmcnt(3)
    v_add_f32 v48, v48, v64
    v_mfma_f32_32x32x16_bf16 v[144:159], a[52:55], v[224:227], v[144:159]
    buffer_load_dwordx4 v[224:227], v111, s[12:15], s6 offen sc1
    s_waitcnt vmcnt(13)
    v_add_f32 v49, v49, v65
    v_mfma_f32_32x32x16_bf16 v[128:143], a[56:59], v[228:231], v[128:143]
    v_add_f32 v50, v50, v66
    v_add_f32 v51, v51, v67
    v_mfma_f32_32x32x16_bf16 v[144:159], a[60:63], v[228:231], v[144:159]
    buffer_load_dwordx4 v[228:231], v111, s[12:15], s6 offen offset:1024 sc1
    s_waitcnt vmcnt(13)
    s_waitcnt lgkmcnt(2)
    v_add_f32 v52, v52, v68
    v_mfma_f32_32x32x16_bf16 v[128:143], a[64:67], v[232:235], v[128:143]
    v_add_f32 v53, v53, v69
    v_add_f32 v54, v54, v70
    v_mfma_f32_32x32x16_bf16 v[144:159], a[68:71], v[232:235], v[144:159]
    buffer_load_dwordx4 v[232:235], v111, s[12:15], s6 offen offset:2048 sc1
    s_waitcnt vmcnt(13)
    v_add_f32 v55, v55, v71
    s_waitcnt lgkmcnt(1)
    v_mfma_f32_32x32x16_bf16 v[128:143], a[72:75], v[236:239], v[128:143]
    v_add_f32 v56, v56, v72
    v_add_f32 v57, v57, v73
    v_mfma_f32_32x32x16_bf16 v[144:159], a[76:79], v[236:239], v[144:159]
    buffer_load_dwordx4 v[236:239], v111, s[12:15], s6 offen offset:3072 sc1
    s_waitcnt vmcnt(13)
    v_add_f32 v58, v58, v74
    v_mfma_f32_32x32x16_bf16 v[128:143], a[80:83], v[240:243], v[128:143]
    v_add_f32 v59, v59, v75
    s_waitcnt lgkmcnt(0)
    v_mfma_f32_32x32x16_bf16 v[144:159], a[84:87], v[240:243], v[144:159]
    buffer_load_dwordx4 v[240:243], v111, s[12:15], s7 offen sc1
    s_waitcnt vmcnt(13)
    v_add_f32 v60, v60, v76
    v_add_f32 v61, v61, v77
    v_mfma_f32_32x32x16_bf16 v[128:143], a[88:91], v[244:247], v[128:143]
    v_add_f32 v62, v62, v78
    v_add_f32 v63, v63, v79
    v_mfma_f32_32x32x16_bf16 v[144:159], a[92:95], v[244:247], v[144:159]
    buffer_load_dwordx4 v[244:247], v111, s[12:15], s7 offen offset:1024 sc1
    s_waitcnt vmcnt(13)
    v_mfma_f32_32x32x16_bf16 v[160:175], a[128:131], v[192:195], 0
    v_mfma_f32_32x32x16_bf16 v[176:191], a[132:135], v[192:195], 0
    buffer_load_dwordx4 v[192:195], v111, s[12:15], s7 offen offset:2048 sc1
    s_waitcnt vmcnt(13)
    v_mfma_f32_32x32x16_bf16 v[160:175], a[136:139], v[196:199], v[160:175]
    v_mfma_f32_32x32x16_bf16 v[176:191], a[140:143], v[196:199], v[176:191]
    buffer_load_dwordx4 v[196:199], v111, s[12:15], s7 offen offset:3072 sc1
    s_waitcnt vmcnt(13)
    ds_write_b128 v104, v[128:131] offset:0
    ds_write_b128 v104, v[132:135] offset:1024
    v_mfma_f32_32x32x16_bf16 v[160:175], a[144:147], v[200:203], v[160:175]
    ds_write_b128 v104, v[136:139] offset:2048
    v_mfma_f32_32x32x16_bf16 v[176:191], a[148:151], v[200:203], v[176:191]
    buffer_load_dwordx4 v[200:203], v111, s[12:15], s8 offen sc1
    s_waitcnt vmcnt(13)
    ds_write_b128 v104, v[140:143] offset:3072
    ds_write_b128 v105, v[144:147] offset:0
    v_mfma_f32_32x32x16_bf16 v[160:175], a[152:155], v[204:207], v[160:175]
    ds_write_b128 v105, v[148:151] offset:1024
    ds_write_b128 v105, v[152:155] offset:2048
    v_mfma_f32_32x32x16_bf16 v[176:191], a[156:159], v[204:207], v[176:191]
    buffer_load_dwordx4 v[204:207], v111, s[12:15], s8 offen offset:1024 sc1
    s_waitcnt vmcnt(13)
    ds_write_b128 v105, v[156:159] offset:3072
    v_mfma_f32_32x32x16_bf16 v[160:175], a[160:163], v[208:211], v[160:175]
    s_waitcnt lgkmcnt(0)
    s_barrier
    v_mfma_f32_32x32x16_bf16 v[176:191], a[164:167], v[208:211], v[176:191]
    buffer_load_dwordx4 v[208:211], v111, s[12:15], s8 offen offset:2048 sc1
    s_waitcnt vmcnt(13)
    ds_read_b128 v[64:67], v107 offset:0
    v_mfma_f32_32x32x16_bf16 v[160:175], a[168:171], v[212:215], v[160:175]
    ds_read_b128 v[68:71], v107 offset:1024
    ds_read_b128 v[72:75], v107 offset:2048
    v_mfma_f32_32x32x16_bf16 v[176:191], a[172:175], v[212:215], v[176:191]
    buffer_load_dwordx4 v[212:215], v111, s[12:15], s8 offen offset:3072 sc1
    s_waitcnt vmcnt(13)
    ds_read_b128 v[76:79], v107 offset:3072
    ds_read_b128 v[128:131], v108 offset:0
    v_mfma_f32_32x32x16_bf16 v[160:175], a[176:179], v[216:219], v[160:175]
    ds_read_b128 v[132:135], v108 offset:1024
    v_mfma_f32_32x32x16_bf16 v[176:191], a[180:183], v[216:219], v[176:191]
    buffer_load_dwordx4 v[216:219], v111, s[12:15], s9 offen sc1
    s_waitcnt vmcnt(13)
    ds_read_b128 v[136:139], v108 offset:2048
    ds_read_b128 v[140:143], v108 offset:3072
    v_mfma_f32_32x32x16_bf16 v[160:175], a[184:187], v[220:223], v[160:175]
    s_waitcnt lgkmcnt(0)
    v_add_f32 v64, v64, v128
    v_mfma_f32_32x32x16_bf16 v[176:191], a[188:191], v[220:223], v[176:191]
    buffer_load_dwordx4 v[220:223], v111, s[12:15], s9 offen offset:1024 sc1
    s_waitcnt vmcnt(13)
    v_add_f32 v65, v65, v129
    v_mfma_f32_32x32x16_bf16 v[160:175], a[192:195], v[224:227], v[160:175]
    v_add_f32 v66, v66, v130
    v_add_f32 v67, v67, v131
    v_mfma_f32_32x32x16_bf16 v[176:191], a[196:199], v[224:227], v[176:191]
    buffer_load_dwordx4 v[224:227], v111, s[12:15], s9 offen offset:2048 sc1
    s_waitcnt vmcnt(13)
    v_add_f32 v68, v68, v132
    v_add_f32 v69, v69, v133
    v_mfma_f32_32x32x16_bf16 v[160:175], a[200:203], v[228:231], v[160:175]
    v_add_f32 v70, v70, v134
    v_mfma_f32_32x32x16_bf16 v[176:191], a[204:207], v[228:231], v[176:191]
    buffer_load_dwordx4 v[228:231], v111, s[12:15], s9 offen offset:3072 sc1
    s_waitcnt vmcnt(13)
    v_add_f32 v71, v71, v135
    v_add_f32 v72, v72, v136
    v_mfma_f32_32x32x16_bf16 v[160:175], a[208:211], v[232:235], v[160:175]
    v_add_f32 v73, v73, v137
    v_mfma_f32_32x32x16_bf16 v[176:191], a[212:215], v[232:235], v[176:191]
    buffer_load_dwordx4 v[232:235], v111, s[12:15], s10 offen sc1
    s_waitcnt vmcnt(13)
    v_add_f32 v74, v74, v138
    v_add_f32 v75, v75, v139
    v_mfma_f32_32x32x16_bf16 v[160:175], a[216:219], v[236:239], v[160:175]
    v_add_f32 v76, v76, v140
    v_add_f32 v77, v77, v141
    v_mfma_f32_32x32x16_bf16 v[176:191], a[220:223], v[236:239], v[176:191]
    buffer_load_dwordx4 v[236:239], v111, s[12:15], s10 offen offset:1024 sc1
    s_waitcnt vmcnt(13)
    v_add_f32 v78, v78, v142
    v_mfma_f32_32x32x16_bf16 v[160:175], a[224:227], v[240:243], v[160:175]
    v_add_f32 v79, v79, v143
    v_lshlrev_b32 v144, 16, v20
    v_mfma_f32_32x32x16_bf16 v[176:191], a[228:231], v[240:243], v[176:191]
    buffer_load_dwordx4 v[240:243], v111, s[12:15], s10 offen offset:2048 sc1
    s_waitcnt vmcnt(13)
    v_and_b32 v145, 0xffff0000, v20
    v_lshlrev_b32 v146, 16, v21
    v_mfma_f32_32x32x16_bf16 v[160:175], a[232:235], v[244:247], v[160:175]
    v_and_b32 v147, 0xffff0000, v21
    v_mfma_f32_32x32x16_bf16 v[176:191], a[236:239], v[244:247], v[176:191]
    buffer_load_dwordx4 v[244:247], v111, s[12:15], s10 offen offset:3072 sc1
    s_waitcnt vmcnt(13)
    v_lshlrev_b32 v148, 16, v22
    v_and_b32 v149, 0xffff0000, v22
    v_mfma_f32_32x32x16_bf16 v[160:175], a[240:243], v[192:195], v[160:175]
    v_lshlrev_b32 v150, 16, v23
    v_and_b32 v151, 0xffff0000, v23
    v_mfma_f32_32x32x16_bf16 v[176:191], a[244:247], v[192:195], v[176:191]
    s_waitcnt vmcnt(12)
    v_lshlrev_b32 v152, 16, v24
    v_mfma_f32_32x32x16_bf16 v[160:175], a[248:251], v[196:199], v[160:175]
    v_and_b32 v153, 0xffff0000, v24
    v_lshlrev_b32 v154, 16, v25
    v_mfma_f32_32x32x16_bf16 v[176:191], a[252:255], v[196:199], v[176:191]
    s_waitcnt vmcnt(11)
    v_and_b32 v155, 0xffff0000, v25
    v_mfma_f32_32x32x16_bf16 v[160:175], a[0:3], v[200:203], v[160:175]
    v_lshlrev_b32 v156, 16, v26
    v_and_b32 v157, 0xffff0000, v26
    v_mfma_f32_32x32x16_bf16 v[176:191], a[4:7], v[200:203], v[176:191]
    s_waitcnt vmcnt(10)
    v_lshlrev_b32 v158, 16, v27
    v_and_b32 v159, 0xffff0000, v27
    v_mfma_f32_32x32x16_bf16 v[160:175], a[8:11], v[204:207], v[160:175]
    v_add_f32 v64, v64, v144
    v_mfma_f32_32x32x16_bf16 v[176:191], a[12:15], v[204:207], v[176:191]
    s_waitcnt vmcnt(9)
    v_add_f32 v65, v65, v145
    v_add_f32 v66, v66, v146
    v_mfma_f32_32x32x16_bf16 v[160:175], a[16:19], v[208:211], v[160:175]
    v_add_f32 v67, v67, v147
    v_add_f32 v68, v68, v148
    v_mfma_f32_32x32x16_bf16 v[176:191], a[20:23], v[208:211], v[176:191]
    s_waitcnt vmcnt(8)
    v_add_f32 v69, v69, v149
    v_mfma_f32_32x32x16_bf16 v[160:175], a[24:27], v[212:215], v[160:175]
    v_add_f32 v70, v70, v150
    v_add_f32 v71, v71, v151
    v_mfma_f32_32x32x16_bf16 v[176:191], a[28:31], v[212:215], v[176:191]
    s_waitcnt vmcnt(7)
    v_add_f32 v72, v72, v152
    v_mfma_f32_32x32x16_bf16 v[160:175], a[32:35], v[216:219], v[160:175]
    v_add_f32 v73, v73, v153
    v_add_f32 v74, v74, v154
    v_mfma_f32_32x32x16_bf16 v[176:191], a[36:39], v[216:219], v[176:191]
    s_waitcnt vmcnt(6)
    v_add_f32 v75, v75, v155
    v_add_f32 v76, v76, v156
    v_mfma_f32_32x32x16_bf16 v[160:175], a[40:43], v[220:223], v[160:175]
    v_add_f32 v77, v77, v157
    v_mfma_f32_32x32x16_bf16 v[176:191], a[44:47], v[220:223], v[176:191]
    s_waitcnt vmcnt(5)
    v_add_f32 v78, v78, v158
    v_add_f32 v79, v79, v159
    v_mfma_f32_32x32x16_bf16 v[160:175], a[48:51], v[224:227], v[160:175]
    v_lshlrev_b32 v144, 16, v12
    v_and_b32 v145, 0xffff0000, v12
    v_mfma_f32_32x32x16_bf16 v[176:191], a[52:55], v[224:227], v[176:191]
    s_waitcnt vmcnt(4)
    v_lshlrev_b32 v146, 16, v13
    v_mfma_f32_32x32x16_bf16 v[160:175], a[56:59], v[228:231], v[160:175]
    v_and_b32 v147, 0xffff0000, v13
    v_lshlrev_b32 v148, 16, v14
    v_mfma_f32_32x32x16_bf16 v[176:191], a[60:63], v[228:231], v[176:191]
    s_waitcnt vmcnt(3)
    v_and_b32 v149, 0xffff0000, v14
    v_lshlrev_b32 v150, 16, v15
    v_mfma_f32_32x32x16_bf16 v[160:175], a[64:67], v[232:235], v[160:175]
    v_and_b32 v151, 0xffff0000, v15
    v_mfma_f32_32x32x16_bf16 v[176:191], a[68:71], v[232:235], v[176:191]
    s_waitcnt vmcnt(2)
    v_lshlrev_b32 v152, 16, v16
    v_and_b32 v153, 0xffff0000, v16
    v_mfma_f32_32x32x16_bf16 v[160:175], a[72:75], v[236:239], v[160:175]
    v_lshlrev_b32 v154, 16, v17
    v_mfma_f32_32x32x16_bf16 v[176:191], a[76:79], v[236:239], v[176:191]
    s_waitcnt vmcnt(1)
    v_and_b32 v155, 0xffff0000, v17
    v_lshlrev_b32 v156, 16, v18
    v_mfma_f32_32x32x16_bf16 v[160:175], a[80:83], v[240:243], v[160:175]
    v_and_b32 v157, 0xffff0000, v18
    v_lshlrev_b32 v158, 16, v19
    v_mfma_f32_32x32x16_bf16 v[176:191], a[84:87], v[240:243], v[176:191]
    s_waitcnt vmcnt(0)
    v_and_b32 v159, 0xffff0000, v19
    v_mfma_f32_32x32x16_bf16 v[160:175], a[88:91], v[244:247], v[160:175]
    v_mov_b32 v4, 0xbfb8aa3b
    v_lshl_add_u32 v6, v36, 4, v1
    v_mfma_f32_32x32x16_bf16 v[176:191], a[92:95], v[244:247], v[176:191]
    s_nop 11
    ds_write_b128 v106, v[176:179] offset:0
    ds_write_b128 v106, v[180:183] offset:1024
    ds_write_b128 v106, v[184:187] offset:2048
    ds_write_b128 v106, v[188:191] offset:3072
    v_pk_add_f32 v[64:65], v[64:65], v[160:161]
    v_pk_add_f32 v[66:67], v[66:67], v[162:163]
    v_pk_add_f32 v[68:69], v[68:69], v[164:165]
    v_pk_add_f32 v[70:71], v[70:71], v[166:167]
    v_pk_add_f32 v[72:73], v[72:73], v[168:169]
    v_pk_add_f32 v[74:75], v[74:75], v[170:171]
    v_pk_add_f32 v[76:77], v[76:77], v[172:173]
    v_pk_add_f32 v[78:79], v[78:79], v[174:175]
    s_waitcnt lgkmcnt(0)
    s_barrier
    ds_read_b128 v[128:131], v109 offset:0
    ds_read_b128 v[132:135], v109 offset:1024
    ds_read_b128 v[136:139], v109 offset:2048
    ds_read_b128 v[140:143], v109 offset:3072
    s_waitcnt lgkmcnt(2)
    v_pk_add_f32 v[64:65], v[64:65], v[128:129]
    v_pk_add_f32 v[66:67], v[66:67], v[130:131]
    v_pk_add_f32 v[68:69], v[68:69], v[132:133]
    v_pk_add_f32 v[70:71], v[70:71], v[134:135]
    v_pk_mul_f32 v[160:161], v[64:65], v[4:5] op_sel_hi:[1,0]
    v_pk_mul_f32 v[162:163], v[66:67], v[4:5] op_sel_hi:[1,0]
    v_pk_mul_f32 v[164:165], v[68:69], v[4:5] op_sel_hi:[1,0]
    v_pk_mul_f32 v[166:167], v[70:71], v[4:5] op_sel_hi:[1,0]
    v_exp_f32 v160, v160
    v_exp_f32 v161, v161
    v_exp_f32 v162, v162
    v_exp_f32 v163, v163
    v_exp_f32 v164, v164
    v_exp_f32 v165, v165
    v_exp_f32 v166, v166
    v_exp_f32 v167, v167
    v_pk_mul_f32 v[64:65], v[64:65], v[48:49]
    v_pk_mul_f32 v[66:67], v[66:67], v[50:51]
    v_pk_mul_f32 v[68:69], v[68:69], v[52:53]
    v_pk_mul_f32 v[70:71], v[70:71], v[54:55]
    v_pk_add_f32 v[160:161], v[160:161], 1.0 op_sel_hi:[1,0]
    v_pk_add_f32 v[162:163], v[162:163], 1.0 op_sel_hi:[1,0]
    v_pk_add_f32 v[164:165], v[164:165], 1.0 op_sel_hi:[1,0]
    v_pk_add_f32 v[166:167], v[166:167], 1.0 op_sel_hi:[1,0]
    v_rcp_f32 v160, v160
    v_rcp_f32 v161, v161
    v_rcp_f32 v162, v162
    v_rcp_f32 v163, v163
    v_rcp_f32 v164, v164
    v_rcp_f32 v165, v165
    v_rcp_f32 v166, v166
    v_rcp_f32 v167, v167
    v_pk_fma_f32 v[64:65], v[64:65], v[160:161], v[144:145]
    v_pk_fma_f32 v[66:67], v[66:67], v[162:163], v[146:147]
    v_pk_fma_f32 v[68:69], v[68:69], v[164:165], v[148:149]
    v_pk_fma_f32 v[70:71], v[70:71], v[166:167], v[150:151]
    v_cvt_pk_bf16_f32 v176, v64, v65
    v_cvt_pk_bf16_f32 v177, v66, v67
    v_cvt_pk_bf16_f32 v178, v68, v69
    v_cvt_pk_bf16_f32 v179, v70, v71
    s_nop 0
    v_permlane32_swap_b32 v176, v178
    v_permlane32_swap_b32 v177, v179
    buffer_store_dwordx4 v[176:179], v6, s[36:39], 0 offen nt
    s_waitcnt lgkmcnt(0)
    v_pk_add_f32 v[72:73], v[72:73], v[136:137]
    v_pk_add_f32 v[74:75], v[74:75], v[138:139]
    v_pk_add_f32 v[76:77], v[76:77], v[140:141]
    v_pk_add_f32 v[78:79], v[78:79], v[142:143]
    v_pk_mul_f32 v[168:169], v[72:73], v[4:5] op_sel_hi:[1,0]
    v_pk_mul_f32 v[170:171], v[74:75], v[4:5] op_sel_hi:[1,0]
    v_pk_mul_f32 v[172:173], v[76:77], v[4:5] op_sel_hi:[1,0]
    v_pk_mul_f32 v[174:175], v[78:79], v[4:5] op_sel_hi:[1,0]
    v_exp_f32 v168, v168
    v_exp_f32 v169, v169
    v_exp_f32 v170, v170
    v_exp_f32 v171, v171
    v_exp_f32 v172, v172
    v_exp_f32 v173, v173
    v_exp_f32 v174, v174
    v_exp_f32 v175, v175
    v_pk_mul_f32 v[72:73], v[72:73], v[56:57]
    v_pk_mul_f32 v[74:75], v[74:75], v[58:59]
    v_pk_mul_f32 v[76:77], v[76:77], v[60:61]
    v_pk_mul_f32 v[78:79], v[78:79], v[62:63]
    v_pk_add_f32 v[168:169], v[168:169], 1.0 op_sel_hi:[1,0]
    v_pk_add_f32 v[170:171], v[170:171], 1.0 op_sel_hi:[1,0]
    v_pk_add_f32 v[172:173], v[172:173], 1.0 op_sel_hi:[1,0]
    v_pk_add_f32 v[174:175], v[174:175], 1.0 op_sel_hi:[1,0]
    v_rcp_f32 v168, v168
    v_rcp_f32 v169, v169
    v_rcp_f32 v170, v170
    v_rcp_f32 v171, v171
    v_rcp_f32 v172, v172
    v_rcp_f32 v173, v173
    v_rcp_f32 v174, v174
    v_rcp_f32 v175, v175
    v_pk_fma_f32 v[72:73], v[72:73], v[168:169], v[152:153]
    v_pk_fma_f32 v[74:75], v[74:75], v[170:171], v[154:155]
    v_pk_fma_f32 v[76:77], v[76:77], v[172:173], v[156:157]
    v_pk_fma_f32 v[78:79], v[78:79], v[174:175], v[158:159]
    v_cvt_pk_bf16_f32 v180, v72, v73
    v_cvt_pk_bf16_f32 v181, v74, v75
    v_cvt_pk_bf16_f32 v182, v76, v77
    v_cvt_pk_bf16_f32 v183, v78, v79
    s_nop 0
    v_permlane32_swap_b32 v180, v182
    v_permlane32_swap_b32 v181, v183
    buffer_store_dwordx4 v[180:183], v6, s[36:39], 0 offen offset:32 nt
L_end:
    s_endpgm
L_code_end:
.section .rodata,"a"
.p2align 6
.amdhsa_kernel recurrent_scan__spectral_gfnet__mixer_s_mlp__prompt_kernel
  .amdhsa_next_free_vgpr 512
  .amdhsa_next_free_sgpr 102
  .amdhsa_accum_offset 256
  .amdhsa_group_segment_fixed_size 0
  .amdhsa_kernarg_size 88
  .amdhsa_user_sgpr_count 2
  .amdhsa_user_sgpr_kernarg_segment_ptr 1
  .amdhsa_system_sgpr_workgroup_id_x 1
.end_amdhsa_kernel
```
